```python
import torch

def _softmax(x, axis=-1):
    return torch.softmax(x, dim=axis)
def _gelu(x):
    return torch.nn.functional.gelu(x, approximate="tanh")
def _silu(x):
    return torch.nn.functional.silu(x)
def _sigmoid(x):
    return torch.sigmoid(x)
def _layernorm(x, axis=-1, eps=1e-5):
    m = x.mean(dim=axis, keepdim=True)
    v = x.var(dim=axis, keepdim=True, unbiased=False)
    return (x - m) / torch.sqrt(v + eps)
def _scatter_add(tgt, idx, src, axis=0):
    return tgt.clone().index_add_(axis, idx, src)
def _segment_sum(src, seg, n):
    out = torch.zeros((n,) + src.shape[1:], dtype=src.dtype)
    return out.index_add_(0, seg, src)
def _pad(x, pw):
    flat = tuple(v for pair in reversed(pw) for v in pair)
    return torch.nn.functional.pad(x, flat)

kernel_name = 'recurrent_scan__gqa_block_cached__mixer_channel_mlp__decode'

def setup_inputs():

    _w = (lambda a: (lambda t: t.to(torch.bfloat16) if t.is_floating_point() else t)(torch.as_tensor(a)))
    def _A_setup():
        B, Sq, D = 2, 1, 512
        Hq, Hkv, Sk, Dh = 32, 8, 8192, 128
        assert Hq % Hkv == 0, (Hq, Hkv)
        return {
            "x": _w((lambda *s: torch.randn(*s, dtype=torch.bfloat16) * 0.1)(B, Sq, D)),
            "k_cache": _w((lambda *s: torch.randn(*s, dtype=torch.bfloat16) * 0.8)(B, Hkv, Sk, Dh)),
            "v_cache": _w((lambda *s: torch.randn(*s, dtype=torch.bfloat16) * 3.2)(B, Hkv, Sk, Dh)),
            "wq": _w((lambda *s: torch.randn(*s, dtype=torch.bfloat16) * 0.8)(D, Hq * Dh) * (D ** -0.5)),
            "wo": _w((lambda *s: torch.randn(*s, dtype=torch.bfloat16) * 3.2)(Hq * Dh, D) * ((Hq * Dh) ** -0.5)),
        }
    _A_in = _A_setup()

    def _B_setup():
        B, S, D, F = 2, 1, 512, 1792
        return {
            "x": _w((lambda *s: torch.randn(*s, dtype=torch.bfloat16) * 0.1)(B, S, D)),
            "w1": _w((lambda *s: torch.randn(*s, dtype=torch.bfloat16) * 3.2)(D, F) * (D ** -0.5)),
            "b1": _w((lambda *s: torch.randn(*s, dtype=torch.bfloat16) * 3.2)(F)),
            "w2": _w((lambda *s: torch.randn(*s, dtype=torch.bfloat16) * 3.2)(F, D) * (F ** -0.5)),
            "b2": _w((lambda *s: torch.randn(*s, dtype=torch.bfloat16) * 3.2)(D)),
        }
    _B_in = _B_setup()

    return {
        "A_x": _A_in["x"],
        "A_k_cache": _A_in["k_cache"],
        "A_v_cache": _A_in["v_cache"],
        "A_wq": _A_in["wq"],
        "A_wo": _A_in["wo"],
        "B_x": _B_in["x"],
        "B_w1": _B_in["w1"],
        "B_b1": _B_in["b1"],
        "B_w2": _B_in["w2"],
        "B_b2": _B_in["b2"],
    }

def reference(A_x, A_k_cache, A_v_cache, A_wq, A_wo, B_x, B_w1, B_b1, B_w2, B_b2):
    def _A_ref(x, k_cache, v_cache, wq, wo):
        B, Sq, D = x.shape
        Hq, Dh = 32, 128
        Hkv = k_cache.shape[1]
        rep = Hq // Hkv
        q = (lambda x, *d: x.permute(*d))((x @ wq).reshape(B, Sq, Hq, Dh), 0, 2, 1, 3)
        k = (lambda x, n, axis: torch.repeat_interleave(x, n, dim=axis))(k_cache, rep, axis=1)
        v = (lambda x, n, axis: torch.repeat_interleave(x, n, dim=axis))(v_cache, rep, axis=1)
        scores = torch.einsum("bhqd,bhkd->bhqk", q, k) * (Dh ** -0.5)
        p = _softmax(scores, axis=-1)
        o = torch.einsum("bhqk,bhkd->bhqd", p, v)
        return (lambda x, *d: x.permute(*d))(o, 0, 2, 1, 3).reshape(B, Sq, Hq * Dh) @ wo

    def _B_ref(x, w1, b1, w2, b2):
        y = _layernorm(x, axis=-1)
        h = _gelu(torch.einsum("bsd,df->bsf", y, w1) + b1)
        return torch.einsum("bsf,fd->bsd", h, w2) + b2

    x = A_x
    xn = _layernorm(x, axis=-1)
    s = _A_ref(xn, A_k_cache, A_v_cache, A_wq, A_wo)
    g = _silu(_B_ref(xn, B_w1, B_b1, B_w2, B_b2))
    return x + s * g
```

```asm
; @launch grid=(256,1,1) block=(1024,1,1) lds=59392
.amdgcn_target "amdgcn-amd-amdhsa--gfx950"
.text
.globl recurrent_scan__gqa_block_cached__mixer_channel_mlp__decode_kernel
.p2align 8
.type recurrent_scan__gqa_block_cached__mixer_channel_mlp__decode_kernel,@function
recurrent_scan__gqa_block_cached__mixer_channel_mlp__decode_kernel:
    s_load_dwordx16 s[16:31], s[0:1], 0
    s_load_dwordx8 s[32:39], s[0:1], 64
    s_load_dwordx2 s[40:41], s[0:1], 96
    s_cmp_ge_u32 s2, 256
    s_cbranch_scc1 L_end
    v_cmp_gt_u32 vcc, 0x80, v0
    s_cbranch_vccz L_nopf
    s_getpc_b64 s[42:43]
L_pc:
    v_lshlrev_b32 v4, 7, v0
    v_min_u32 v4, L_codeend-L_pc-4, v4
    global_load_dword v127, v4, s[42:43]
L_nopf:
    v_lshrrev_b32 v4, 6, v0
    v_and_b32 v1, 63, v0
    v_readfirstlane_b32 s3, v4
    s_and_b32 s75, s2, 15
    s_lshl_b32 s75, s75, 21
    s_lshr_b32 s73, s2, 4
    s_lshl_b32 s73, s73, 15
    s_or_b32 s75, s75, s73
    s_mul_i32 s79, s2, 0x9e3779b1
    s_lshr_b32 s79, s79, 9
    s_and_b32 s79, s79, 0x187800
    s_or_b32 s75, s75, s79
    v_bfe_u32 v2, v1, 2, 2
    v_lshlrev_b32 v2, 8, v2
    v_lshrrev_b32 v4, 4, v1
    v_lshl_add_u32 v2, v4, 6, v2
    v_and_b32 v6, 3, v1
    v_lshl_add_u32 v2, v6, 4, v2
    s_mov_b32 s10, 0x2000000
    s_mov_b32 s11, 0x00020000
    s_sub_u32 s76, s3, 4
    s_cbranch_scc1 L_svc
    s_lshl_b32 s73, s76, 11
    s_xor_b32 s96, s75, s73
    s_waitcnt lgkmcnt(0)
    s_mov_b32 s8, s18
    s_mov_b32 s9, s19
    buffer_load_dwordx4 v[16:19], v2, s[8:11], s96 offen offset:0 nt
    buffer_load_dwordx4 v[20:23], v2, s[8:11], s96 offen offset:1024 nt
    s_and_b32 s4, s2, 7
    s_lshr_b32 s5, s2, 3
    v_lshlrev_b32 v3, 4, v1
    v_and_b32 v6, 15, v1
    s_add_u32 s76, s76, 12
    s_and_b32 s73, s76, 15
    s_lshl_b32 s73, s73, 11
    s_lshr_b32 s42, s76, 4
    s_lshl_b32 s42, s42, 19
    s_or_b32 s73, s73, s42
    s_xor_b32 s97, s75, s73
    s_lshl_b32 s76, s3, 1
    s_add_u32 s76, s76, 16
    s_and_b32 s73, s76, 15
    s_lshl_b32 s73, s73, 11
    s_lshr_b32 s42, s76, 4
    s_lshl_b32 s42, s42, 19
    s_or_b32 s73, s73, s42
    s_xor_b32 s98, s75, s73
    s_add_u32 s76, s76, 1
    s_and_b32 s73, s76, 15
    s_lshl_b32 s73, s73, 11
    s_lshr_b32 s42, s76, 4
    s_lshl_b32 s42, s42, 19
    s_or_b32 s73, s73, s42
    s_xor_b32 s99, s75, s73
    s_waitcnt lgkmcnt(0)
    s_load_dword s64, s[40:41], 0
    s_mov_b32 s12, s20
    s_mov_b32 s13, s21
    s_mov_b32 s14, 0x2000000
    s_mov_b32 s15, 0x00020000
    s_mov_b32 s44, s40
    s_mov_b32 s45, s41
    s_mov_b32 s46, 0x10000000
    s_mov_b32 s47, 0x00020000
    s_mov_b32 s69, 0x05040100
    s_mov_b32 s70, 0x07060302
    s_mov_b32 s71, 0x3e0293ee
    s_mov_b32 s77, 0xffff0000
    s_movk_i32 s66, 0xfff
    s_mul_i32 s78, s4, 0x40000
    s_getreg_b32 s67, hwreg(HW_REG_XCC_ID, 0, 4)
    s_barrier
    s_waitcnt vmcnt(1)
    buffer_load_dwordx4 v[24:27], v2, s[8:11], s97 offen offset:0 nt
    s_waitcnt vmcnt(1)
    buffer_load_dwordx4 v[28:31], v2, s[8:11], s97 offen offset:1024 nt
    s_waitcnt vmcnt(1)
    buffer_load_dwordx4 v[32:35], v2, s[8:11], s98 offen offset:0 nt
    s_waitcnt vmcnt(1)
    buffer_load_dwordx4 v[36:39], v2, s[8:11], s98 offen offset:1024 nt
    s_waitcnt vmcnt(1)
    buffer_load_dwordx4 v[40:43], v2, s[8:11], s99 offen offset:0 nt
    s_waitcnt vmcnt(1)
    buffer_load_dwordx4 v[44:47], v2, s[8:11], s99 offen offset:1024 nt
    s_waitcnt vmcnt(1)
    buffer_load_dwordx4 v[48:51], v3, s[12:15], s96 offen offset:0 nt
    s_waitcnt vmcnt(1)
    buffer_load_dwordx4 v[52:55], v3, s[12:15], s96 offen offset:1024 nt
    s_waitcnt vmcnt(1)
    buffer_load_dwordx4 v[56:59], v3, s[12:15], s97 offen offset:0 nt
    buffer_load_dwordx4 v[60:63], v3, s[12:15], s97 offen offset:1024 nt
    buffer_load_dwordx4 v[64:67], v3, s[12:15], s98 offen offset:0 nt
    s_waitcnt vmcnt(5)
L_sphase:
    v_mov_b32 v7, 1024
    s_mov_b32 s75, 800000
L_lw_1:
    ds_read_b32 v12, v7
    ds_read_b128 v[8:11], v2 offset:0
    s_waitcnt lgkmcnt(0)
    v_readfirstlane_b32 s73, v12
    s_cmp_ge_u32 s73, 1
    s_cbranch_scc1 L_lok_2
    s_sub_u32 s75, s75, 1
    s_cmp_eq_u32 s75, 0
    s_cbranch_scc1 L_lok_2
    s_sleep 2
    s_branch L_lw_1
L_lok_2:
    v_mfma_f32_16x16x32_bf16 v[80:83], v[16:19], v[8:11], 0
    v_mfma_f32_16x16x32_bf16 v[84:87], v[20:23], v[8:11], 0
    v_mfma_f32_16x16x32_bf16 v[88:91], v[24:27], v[8:11], 0
    v_mfma_f32_16x16x32_bf16 v[92:95], v[28:31], v[8:11], 0
    v_mfma_f32_16x16x32_bf16 v[96:99], v[32:35], v[8:11], 0
    v_mfma_f32_16x16x32_bf16 v[100:103], v[36:39], v[8:11], 0
    v_mfma_f32_16x16x32_bf16 v[104:107], v[40:43], v[8:11], 0
    v_mfma_f32_16x16x32_bf16 v[108:111], v[44:47], v[8:11], 0
    s_mov_b32 s68, s73
    s_add_u32 s65, s64, 0x01010101
    v_and_b32 v5, 3, v1
    v_lshlrev_b32 v5, 3, v5
    s_and_b32 s73, s65, 15
    v_bfe_u32 v5, s65, v5, 8
    v_lshl_or_b32 v5, v5, 4, s73
    v_lshlrev_b32 v7, 1, v1
    s_lshl_b32 s73, s3, 5
    v_add_u32 v7, s73, v7
    v_mov_b32 v8, 1028
    v_mov_b32 v9, 1
    v_mov_b32_dpp v112, v80 quad_perm:[0,0,0,0] row_mask:0xf bank_mask:0xf
    v_mov_b32_dpp v113, v84 quad_perm:[0,0,0,0] row_mask:0xf bank_mask:0xf
    v_mov_b32_dpp v114, v88 quad_perm:[0,0,0,0] row_mask:0xf bank_mask:0xf
    v_mov_b32_dpp v115, v92 quad_perm:[0,0,0,0] row_mask:0xf bank_mask:0xf
    v_mov_b32_dpp v116, v96 quad_perm:[0,0,0,0] row_mask:0xf bank_mask:0xf
    v_mov_b32_dpp v117, v100 quad_perm:[0,0,0,0] row_mask:0xf bank_mask:0xf
    v_mov_b32_dpp v118, v104 quad_perm:[0,0,0,0] row_mask:0xf bank_mask:0xf
    v_mov_b32_dpp v119, v108 quad_perm:[0,0,0,0] row_mask:0xf bank_mask:0xf
    v_add_f32_dpp v112, v81, v112 quad_perm:[1,1,1,1] row_mask:0xf bank_mask:0xf
    v_add_f32_dpp v113, v85, v113 quad_perm:[1,1,1,1] row_mask:0xf bank_mask:0xf
    v_add_f32_dpp v114, v89, v114 quad_perm:[1,1,1,1] row_mask:0xf bank_mask:0xf
    v_add_f32_dpp v115, v93, v115 quad_perm:[1,1,1,1] row_mask:0xf bank_mask:0xf
    v_add_f32_dpp v116, v97, v116 quad_perm:[1,1,1,1] row_mask:0xf bank_mask:0xf
    v_add_f32_dpp v117, v101, v117 quad_perm:[1,1,1,1] row_mask:0xf bank_mask:0xf
    v_add_f32_dpp v118, v105, v118 quad_perm:[1,1,1,1] row_mask:0xf bank_mask:0xf
    v_add_f32_dpp v119, v109, v119 quad_perm:[1,1,1,1] row_mask:0xf bank_mask:0xf
    v_add_f32_dpp v112, v82, v112 quad_perm:[2,2,2,2] row_mask:0xf bank_mask:0xf
    v_add_f32_dpp v113, v86, v113 quad_perm:[2,2,2,2] row_mask:0xf bank_mask:0xf
    v_add_f32_dpp v114, v90, v114 quad_perm:[2,2,2,2] row_mask:0xf bank_mask:0xf
    v_add_f32_dpp v115, v94, v115 quad_perm:[2,2,2,2] row_mask:0xf bank_mask:0xf
    v_add_f32_dpp v116, v98, v116 quad_perm:[2,2,2,2] row_mask:0xf bank_mask:0xf
    v_add_f32_dpp v117, v102, v117 quad_perm:[2,2,2,2] row_mask:0xf bank_mask:0xf
    v_add_f32_dpp v118, v106, v118 quad_perm:[2,2,2,2] row_mask:0xf bank_mask:0xf
    v_add_f32_dpp v119, v110, v119 quad_perm:[2,2,2,2] row_mask:0xf bank_mask:0xf
    v_add_f32_dpp v112, v83, v112 quad_perm:[3,3,3,3] row_mask:0xf bank_mask:0xf
    v_add_f32_dpp v113, v87, v113 quad_perm:[3,3,3,3] row_mask:0xf bank_mask:0xf
    v_add_f32_dpp v114, v91, v114 quad_perm:[3,3,3,3] row_mask:0xf bank_mask:0xf
    v_add_f32_dpp v115, v95, v115 quad_perm:[3,3,3,3] row_mask:0xf bank_mask:0xf
    v_add_f32_dpp v116, v99, v116 quad_perm:[3,3,3,3] row_mask:0xf bank_mask:0xf
    v_add_f32_dpp v117, v103, v117 quad_perm:[3,3,3,3] row_mask:0xf bank_mask:0xf
    v_add_f32_dpp v118, v107, v118 quad_perm:[3,3,3,3] row_mask:0xf bank_mask:0xf
    v_add_f32_dpp v119, v111, v119 quad_perm:[3,3,3,3] row_mask:0xf bank_mask:0xf
    s_mov_b32 s42, 0x3db504f3
    s_mov_b32 s43, 0x3db504f3
    s_mov_b32 s71, 0x3fb8aa3b
    v_cvt_pk_bf16_f32 v80, v112, v113
    v_cvt_pk_bf16_f32 v81, v114, v115
    v_cvt_pk_bf16_f32 v82, v116, v117
    v_cvt_pk_bf16_f32 v83, v118, v119
    v_lshlrev_b32 v112, 16, v80
    v_and_b32 v113, s77, v80
    v_lshlrev_b32 v114, 16, v81
    v_and_b32 v115, s77, v81
    v_lshlrev_b32 v116, 16, v82
    v_and_b32 v117, s77, v82
    v_lshlrev_b32 v118, 16, v83
    v_and_b32 v119, s77, v83
    v_pk_mul_f32 v[112:113], v[112:113], s[42:43]
    v_pk_mul_f32 v[114:115], v[114:115], s[42:43]
    v_pk_mul_f32 v[116:117], v[116:117], s[42:43]
    v_pk_mul_f32 v[118:119], v[118:119], s[42:43]
    v_cvt_pk_bf16_f32 v80, v112, v113
    v_cvt_pk_bf16_f32 v81, v114, v115
    v_cvt_pk_bf16_f32 v82, v116, v117
    v_cvt_pk_bf16_f32 v83, v118, v119
    v_lshlrev_b32 v112, 16, v80
    v_and_b32 v113, s77, v80
    v_lshlrev_b32 v114, 16, v81
    v_and_b32 v115, s77, v81
    v_lshlrev_b32 v116, 16, v82
    v_and_b32 v117, s77, v82
    v_lshlrev_b32 v118, 16, v83
    v_and_b32 v119, s77, v83
    v_max3_f32 v120, v112, v113, v114
    v_max3_f32 v121, v115, v116, v117
    v_max3_f32 v120, v120, v118, v119
    v_max_f32 v120, v120, v121
    v_mov_b32 v121, v120
    s_nop 1
    v_permlane16_swap_b32 v120, v121
    v_max_f32 v120, v120, v121
    v_mov_b32 v121, v120
    s_nop 1
    v_permlane32_swap_b32 v120, v121
    v_max_f32 v120, v120, v121
    v_mul_f32 v120, s71, v120
    v_fma_f32 v112, v112, s71, -v120
    v_fma_f32 v113, v113, s71, -v120
    v_fma_f32 v114, v114, s71, -v120
    v_fma_f32 v115, v115, s71, -v120
    v_fma_f32 v116, v116, s71, -v120
    v_fma_f32 v117, v117, s71, -v120
    v_fma_f32 v118, v118, s71, -v120
    v_fma_f32 v119, v119, s71, -v120
    v_exp_f32 v112, v112
    v_exp_f32 v113, v113
    v_exp_f32 v114, v114
    v_exp_f32 v115, v115
    v_exp_f32 v116, v116
    v_exp_f32 v117, v117
    v_exp_f32 v118, v118
    v_exp_f32 v119, v119
    v_add_f32 v121, v112, v113
    v_add_f32 v122, v114, v115
    v_add_f32 v123, v116, v117
    v_add_f32 v124, v118, v119
    v_add_f32 v121, v121, v122
    v_add_f32 v123, v123, v124
    v_add_f32 v121, v121, v123
    v_mov_b32 v122, v121
    s_nop 1
    v_permlane16_swap_b32 v121, v122
    v_add_f32 v121, v121, v122
    v_mov_b32 v122, v121
    s_nop 1
    v_permlane32_swap_b32 v121, v122
    v_add_f32 v121, v121, v122
    s_mov_b64 exec, 0x1111
    ds_write_b64 v7, v[120:121] offset:1536
    s_mov_b64 exec, 1
    ds_add_u32 v8, v9
    s_mov_b64 exec, -1
    v_cvt_pk_bf16_f32 v124, v112, v113
    v_cvt_pk_bf16_f32 v125, v114, v115
    v_cvt_pk_bf16_f32 v126, v116, v117
    v_cvt_pk_bf16_f32 v127, v118, v119
    s_cmp_lt_u32 s3, 4
    s_cbranch_scc1 L_svcmid
    buffer_load_dwordx4 v[68:71], v3, s[12:15], s98 offen offset:1024 nt
    buffer_load_dwordx4 v[72:75], v3, s[12:15], s99 offen offset:0 nt
    buffer_load_dwordx4 v[76:79], v3, s[12:15], s99 offen offset:1024 nt
    v_mov_b32 v8, 1040
    s_mov_b64 exec, 1
    ds_add_u32 v8, v9
    s_mov_b64 exec, -1
    v_mov_b32 v8, 1032
L_pphase:
    v_and_b32 v0, 3, v1
    v_cmp_eq_u32 s[48:49], 0, v0
    v_cmp_eq_u32 s[50:51], 1, v0
    v_cmp_eq_u32 s[52:53], 2, v0
    v_cmp_eq_u32 s[54:55], 3, v0
    v_cndmask_b32 v16, 0, v124, s[48:49]
    v_cndmask_b32 v17, 0, v125, s[48:49]
    v_cndmask_b32 v18, 0, v126, s[48:49]
    v_cndmask_b32 v19, 0, v127, s[48:49]
    v_cndmask_b32 v20, 0, v124, s[50:51]
    v_cndmask_b32 v21, 0, v125, s[50:51]
    v_cndmask_b32 v22, 0, v126, s[50:51]
    v_cndmask_b32 v23, 0, v127, s[50:51]
    v_cndmask_b32 v24, 0, v124, s[52:53]
    v_cndmask_b32 v25, 0, v125, s[52:53]
    v_cndmask_b32 v26, 0, v126, s[52:53]
    v_cndmask_b32 v27, 0, v127, s[52:53]
    v_cndmask_b32 v28, 0, v124, s[54:55]
    v_cndmask_b32 v29, 0, v125, s[54:55]
    v_cndmask_b32 v30, 0, v126, s[54:55]
    v_cndmask_b32 v31, 0, v127, s[54:55]
    s_lshl_b32 s73, s3, 11
    v_add_u32 v7, s73, v3
    s_waitcnt vmcnt(6)
    v_add_u32 v10, 64, v8
    s_mov_b64 exec, 1
    ds_add_u32 v10, v9
    s_mov_b64 exec, -1
    v_perm_b32 v80, v52, v48, s69
    v_perm_b32 v84, v52, v48, s70
    v_perm_b32 v88, v53, v49, s69
    v_perm_b32 v92, v53, v49, s70
    v_perm_b32 v96, v54, v50, s69
    v_perm_b32 v100, v54, v50, s70
    v_perm_b32 v104, v55, v51, s69
    v_perm_b32 v108, v55, v51, s70
    s_waitcnt vmcnt(4)
    v_perm_b32 v81, v60, v56, s69
    v_perm_b32 v85, v60, v56, s70
    v_perm_b32 v89, v61, v57, s69
    v_perm_b32 v93, v61, v57, s70
    v_perm_b32 v97, v62, v58, s69
    v_perm_b32 v101, v62, v58, s70
    v_perm_b32 v105, v63, v59, s69
    v_perm_b32 v109, v63, v59, s70
    s_waitcnt vmcnt(2)
    v_perm_b32 v82, v68, v64, s69
    v_perm_b32 v86, v68, v64, s70
    v_perm_b32 v90, v69, v65, s69
    v_perm_b32 v94, v69, v65, s70
    v_perm_b32 v98, v70, v66, s69
    v_perm_b32 v102, v70, v66, s70
    v_perm_b32 v106, v71, v67, s69
    v_perm_b32 v110, v71, v67, s70
    s_waitcnt vmcnt(0)
    v_perm_b32 v83, v76, v72, s69
    v_perm_b32 v87, v76, v72, s70
    v_perm_b32 v91, v77, v73, s69
    v_mfma_f32_16x16x32_bf16 v[32:35], v[16:19], v[80:83], 0
    v_perm_b32 v95, v77, v73, s70
    v_mfma_f32_16x16x32_bf16 v[32:35], v[20:23], v[84:87], v[32:35]
    v_perm_b32 v99, v78, v74, s69
    v_mfma_f32_16x16x32_bf16 v[32:35], v[24:27], v[88:91], v[32:35]
    v_perm_b32 v103, v78, v74, s70
    v_mfma_f32_16x16x32_bf16 v[32:35], v[28:31], v[92:95], v[32:35]
    v_perm_b32 v107, v79, v75, s69
    v_mfma_f32_16x16x32_bf16 v[36:39], v[16:19], v[96:99], 0
    v_perm_b32 v111, v79, v75, s70
    v_mfma_f32_16x16x32_bf16 v[36:39], v[20:23], v[100:103], v[36:39]
    v_mfma_f32_16x16x32_bf16 v[36:39], v[24:27], v[104:107], v[36:39]
    v_mfma_f32_16x16x32_bf16 v[36:39], v[28:31], v[108:111], v[36:39]
    s_nop 1
    ds_write_b128 v7, v[32:35] offset:10240
    s_nop 4
    ds_write_b128 v7, v[36:39] offset:11264
    s_mov_b64 exec, 1
    ds_add_u32 v8, v9
    s_mov_b64 exec, -1
    s_and_b32 s73, s3, 14
    s_cmp_eq_u32 s73, 6
    s_cbranch_scc1 L_wojob
    s_cmp_eq_u32 s73, 4
    s_cbranch_scc1 L_reader
    s_cmp_lg_u32 s3, 8
    s_cbranch_scc1 L_fin
    s_bitcmp0_b32 s2, 0
    s_cbranch_scc1 L_fin
    s_cmp_ge_u32 s2, 128
    s_cbranch_scc1 L_fin
    s_mov_b32 s48, s16
    s_mov_b32 s49, s17
    s_mov_b32 s50, 0x800
    s_mov_b32 s51, 0x00020000
    s_mov_b32 s52, s34
    s_mov_b32 s53, s35
    s_mov_b32 s54, 0x400
    s_mov_b32 s55, 0x00020000
    s_mov_b32 s56, s36
    s_mov_b32 s57, s37
    s_mov_b32 s58, 0x800
    s_mov_b32 s59, 0x00020000
    s_lshr_b32 s79, s2, 5
    s_bfe_u32 s42, s2, 0x10004
    s_bfe_u32 s4, s2, 0x30001
    s_mul_i32 s78, s4, 0x40000
    v_lshl_add_u32 v126, v0, 2, v4
    v_lshlrev_b32 v126, 1, v126
    s_lshl_b32 s43, s4, 7
    s_lshl_b32 s73, s79, 5
    s_add_u32 s43, s43, s73
    buffer_load_ushort v124, v126, s[52:55], s43 offen
    s_lshl_b32 s73, s42, 10
    s_add_u32 s43, s43, s73
    buffer_load_ushort v125, v126, s[48:51], s43 offen
    v_lshrrev_b32 v127, 2, v1
    v_lshlrev_b32 v127, 9, v127
    v_lshl_add_u32 v127, v0, 4, v127
    s_lshl_b32 s42, s42, 8
    s_lshl_b32 s73, s79, 6
    s_add_u32 s42, s42, s73
    s_add_u32 s42, s42, s78
    s_add_u32 s79, s42, 0xc000
    v_mov_b32 v16, 0
    v_mov_b32 v17, 0
    v_mov_b32 v18, 0
    v_mov_b32 v19, 0
    s_lshl_b32 s26, s2, 5
    s_and_b32 s26, s26, 0xe00
    s_add_u32 s26, s26, s78
    s_add_u32 s26, s26, 0x1000
    s_add_u32 s27, s26, 0x2000
    s_load_dword s28, s[40:41], s26 glc
    s_load_dword s29, s[40:41], s27 glc
    s_waitcnt lgkmcnt(0)
    s_not_b32 s30, s28
    s_not_b32 s31, s29
    s_mov_b32 s7, 0
    v_mov_b32 v7, 1052
    s_mov_b32 s75, 800000
L_lw_3:
    ds_read_b32 v8, v7
    s_waitcnt lgkmcnt(0)
    v_readfirstlane_b32 s73, v8
    s_cmp_ge_u32 s73, 4
    s_cbranch_scc1 L_lok_4
    s_sub_u32 s75, s75, 1
    s_cmp_eq_u32 s75, 0
    s_cbranch_scc1 L_lok_4
    s_sleep 2
    s_branch L_lw_3
L_lok_4:
    s_mov_b32 exec_hi, 0xffffff
    buffer_load_dwordx4 v[16:19], v127, s[44:47], s79 offen sc1
    s_mov_b32 exec_hi, -1
    s_waitcnt vmcnt(0)
    v_lshlrev_b32 v124, 16, v124
    v_lshlrev_b32 v125, 16, v125
    s_mov_b32 s7, 2
    s_branch L_fmp
L_fwait:
    v_mov_b32 v7, 1036
    s_mov_b32 s75, 800000
L_lw_5:
    ds_read_b32 v8, v7
    s_waitcnt lgkmcnt(0)
    v_readfirstlane_b32 s73, v8
    s_cmp_ge_u32 s73, 1
    s_cbranch_scc1 L_lok_6
    s_sub_u32 s75, s75, 1
    s_cmp_eq_u32 s75, 0
    s_cbranch_scc1 L_lok_6
    s_sleep 2
    s_branch L_lw_5
L_lok_6:
    v_mov_b32 v7, 1060
    s_mov_b32 s6, 0
    s_mov_b32 s75, 800000
L_race:
    s_mov_b32 s29, s31
    s_load_dword s28, s[40:41], s26 glc
    s_load_dword s29, s[40:41], s27 glc
    s_waitcnt lgkmcnt(1)
    s_cmp_eq_u32 s29, s31
    s_subb_u32 s6, s6, 0
    s_waitcnt lgkmcnt(0)
    s_mov_b32 s28, s30
    s_load_dword s29, s[40:41], s27 glc
    s_load_dword s28, s[40:41], s26 glc
    s_waitcnt lgkmcnt(1)
    s_cmp_eq_u32 s28, s30
    s_addc_u32 s6, s6, 0
    ds_read_b32 v8, v7
    s_waitcnt lgkmcnt(0)
    v_readfirstlane_b32 s73, v8
    s_cmp_ge_u32 s73, 2
    s_cbranch_scc1 L_raced
    s_abs_i32 s73, s6
    s_cmp_ge_u32 s73, 2
    s_cbranch_scc1 L_racew
    s_sub_u32 s75, s75, 1
    s_cmp_lg_u32 s75, 0
    s_cbranch_scc1 L_race
L_racew:
    s_mov_b32 s75, 800000
L_lw_7:
    ds_read_b32 v8, v7
    s_waitcnt lgkmcnt(0)
    v_readfirstlane_b32 s73, v8
    s_cmp_ge_u32 s73, 2
    s_cbranch_scc1 L_lok_8
    s_sub_u32 s75, s75, 1
    s_cmp_eq_u32 s75, 0
    s_cbranch_scc1 L_lok_8
    s_sleep 1
    s_branch L_lw_7
L_lok_8:
L_raced:
    s_cmp_gt_i32 s6, 0
    s_cselect_b32 s73, 0x2000, 0
    s_add_u32 s73, s73, s42
    s_add_u32 s60, s73, 0x20000
    s_add_u32 s61, s73, 0x24000
    s_add_u32 s62, s73, 0x28000
    s_add_u32 s63, s73, 0x2c000
    s_mov_b32 s75, 200000
    s_setprio 2
L_fpoll:
    s_cmp_eq_u32 s7, 1
    s_cbranch_scc1 L_fnomp
    s_mov_b32 exec_hi, 0xffffff
    buffer_load_dwordx4 v[16:19], v127, s[44:47], s79 offen sc1
    s_mov_b32 exec_hi, -1
L_fnomp:
    buffer_load_dwordx4 v[48:51], v127, s[44:47], s60 offen sc1
    buffer_load_dwordx4 v[52:55], v127, s[44:47], s61 offen sc1
    buffer_load_dwordx4 v[56:59], v127, s[44:47], s62 offen sc1
    buffer_load_dwordx4 v[60:63], v127, s[44:47], s63 offen sc1
    s_cbranch_scc1 L_fchk
    s_waitcnt vmcnt(4)
L_fmp:
    s_mov_b32 exec_hi, 0xffffff
    v_xor_b32 v19, v5, v19
    v_and_b32 v20, s66, v19
    v_cmp_ne_u32 vcc, 0, v20
    s_mov_b32 exec_hi, -1
    s_cbranch_vccz L_fg
    s_cmp_eq_u32 s7, 2
    s_mov_b32 s7, 0
    s_cbranch_scc1 L_fwait
    s_branch L_fretry
L_fg:
    v_permlane32_swap_b32 v16, v18
    v_permlane32_swap_b32 v17, v19
    v_add_f32 v16, v16, v18
    v_add_f32 v17, v17, v19
    s_nop 1
    v_permlane16_swap_b32 v16, v17
    v_add_f32 v16, v16, v17
    s_nop 1
    v_add_f32_dpp v16, v16, v16 row_ror:8 row_mask:0xf bank_mask:0xf
    s_nop 1
    v_add_f32_dpp v16, v16, v16 row_ror:4 row_mask:0xf bank_mask:0xf
    v_cvt_pk_bf16_f32 v16, v16, v16
    v_and_b32 v16, s77, v16
    v_add_f32 v16, v16, v124
    v_cvt_pk_bf16_f32 v16, v16, v16
    v_and_b32 v16, s77, v16
    v_mul_f32 v17, 0xbfb8aa3b, v16
    v_exp_f32 v17, v17
    s_nop 0
    v_add_f32 v17, 1.0, v17
    v_rcp_f32 v17, v17
    s_nop 0
    v_mul_f32 v124, v16, v17
    v_cvt_pk_bf16_f32 v124, v124, v124
    v_and_b32 v124, s77, v124
    s_cmp_eq_u32 s7, 2
    s_mov_b32 s7, 1
    s_cbranch_scc1 L_fwait
L_fchk:
    s_waitcnt vmcnt(3)
    v_xor_b32 v51, v5, v51
    s_waitcnt vmcnt(2)
    v_xor_b32 v55, v5, v55
    v_or_b32 v64, v51, v55
    v_pk_add_f32 v[48:49], v[48:49], v[52:53]
    v_pk_add_f32 v[50:51], v[50:51], v[54:55]
    s_waitcnt vmcnt(1)
    v_xor_b32 v59, v5, v59
    v_pk_add_f32 v[48:49], v[48:49], v[56:57]
    v_pk_add_f32 v[50:51], v[50:51], v[58:59]
    s_waitcnt vmcnt(0)
    v_xor_b32 v63, v5, v63
    v_or3_b32 v64, v64, v59, v63
    v_and_b32 v64, s66, v64
    v_cmp_ne_u32 vcc, 0, v64
    v_pk_add_f32 v[48:49], v[48:49], v[60:61]
    v_pk_add_f32 v[50:51], v[50:51], v[62:63]
    s_cbranch_vccz L_fok
L_fretry:
    s_waitcnt vmcnt(0)
    s_sub_u32 s75, s75, 1
    s_cmp_lg_u32 s75, 0
    s_cbranch_scc1 L_fpoll
L_fok:
    s_nop 0
    v_permlane32_swap_b32 v48, v50
    v_permlane32_swap_b32 v49, v51
    v_add_f32 v48, v48, v50
    v_add_f32 v49, v49, v51
    s_nop 1
    v_permlane16_swap_b32 v48, v49
    v_add_f32 v48, v48, v49
    s_nop 1
    v_add_f32_dpp v48, v48, v48 row_ror:8 row_mask:0xf bank_mask:0xf
    s_nop 1
    v_add_f32_dpp v48, v48, v48 row_ror:4 row_mask:0xf bank_mask:0xf
    v_cvt_pk_bf16_f32 v48, v48, v48
    v_and_b32 v48, s77, v48
    v_mul_f32 v48, v48, v124
    v_cvt_pk_bf16_f32 v48, v48, v48
    v_and_b32 v48, s77, v48
    v_add_f32 v48, v48, v125
    v_cvt_pk_bf16_f32 v48, v48, v48
    s_mov_b32 exec_lo, 0x000f000f
    s_mov_b32 exec_hi, 0x000f000f
    buffer_store_short v48, v126, s[56:59], s43 offen nt
    s_cmp_gt_u32 s2, 1
    s_cbranch_scc1 L_fin0
    s_mov_b64 exec, 1
    v_mov_b32 v49, s65
    v_mov_b32 v50, 0
    buffer_store_dword v49, v50, s[44:47], 0 offen nt
L_fin0:
    s_mov_b64 exec, -1
    s_branch L_fin
L_reader:
    s_and_b32 s43, s3, 1
    s_lshl_b32 s43, s43, 10
    v_add_u32 v11, s43, v3
    s_lshl_b32 s42, s5, 11
    s_add_u32 s42, s42, s78
    s_add_u32 s42, s42, s43
    s_add_u32 s42, s42, 0x10000
    s_mov_b64 exec, 0xff
    v_lshlrev_b32 v9, 7, v1
    buffer_load_dword v125, v9, s[44:47], s42 offen sc1
    s_mov_b64 exec, -1
    v_mov_b32 v7, 1028
    v_lshlrev_b32 v10, 5, v6
    v_lshl_add_u32 v10, v4, 3, v10
    s_mov_b32 s75, 800000
L_lw_9:
    ds_read_b32 v8, v7
    ds_read_b64 v[16:17], v10 offset:1536
    s_waitcnt lgkmcnt(0)
    v_readfirstlane_b32 s73, v8
    s_cmp_ge_u32 s73, 16
    s_cbranch_scc1 L_lok_10
    s_sub_u32 s75, s75, 1
    s_cmp_eq_u32 s75, 0
    s_cbranch_scc1 L_lok_10
    s_sleep 2
    s_branch L_lw_9
L_lok_10:
    v_mov_b32 v20, v16
    s_nop 1
    v_max_f32_dpp v20, v20, v20 row_ror:8 row_mask:0xf bank_mask:0xf
    s_nop 1
    v_max_f32_dpp v20, v20, v20 row_ror:4 row_mask:0xf bank_mask:0xf
    s_nop 1
    v_max_f32_dpp v20, v20, v20 row_ror:2 row_mask:0xf bank_mask:0xf
    s_nop 1
    v_max_f32_dpp v20, v20, v20 row_ror:1 row_mask:0xf bank_mask:0xf
    v_sub_f32 v16, v16, v20
    v_exp_f32 v14, v16
    s_nop 1
    v_mov_b32_dpp v28, v14 row_newbcast:0 row_mask:0xf bank_mask:0xf
    v_mov_b32_dpp v29, v14 row_newbcast:1 row_mask:0xf bank_mask:0xf
    v_mov_b32_dpp v30, v14 row_newbcast:2 row_mask:0xf bank_mask:0xf
    v_mov_b32_dpp v31, v14 row_newbcast:3 row_mask:0xf bank_mask:0xf
    v_mov_b32_dpp v32, v14 row_newbcast:4 row_mask:0xf bank_mask:0xf
    v_mov_b32_dpp v33, v14 row_newbcast:5 row_mask:0xf bank_mask:0xf
    v_mov_b32_dpp v34, v14 row_newbcast:6 row_mask:0xf bank_mask:0xf
    v_mov_b32_dpp v35, v14 row_newbcast:7 row_mask:0xf bank_mask:0xf
    v_mov_b32_dpp v36, v14 row_newbcast:8 row_mask:0xf bank_mask:0xf
    v_mov_b32_dpp v37, v14 row_newbcast:9 row_mask:0xf bank_mask:0xf
    v_mov_b32_dpp v38, v14 row_newbcast:10 row_mask:0xf bank_mask:0xf
    v_mov_b32_dpp v39, v14 row_newbcast:11 row_mask:0xf bank_mask:0xf
    v_mov_b32_dpp v40, v14 row_newbcast:12 row_mask:0xf bank_mask:0xf
    v_mov_b32_dpp v41, v14 row_newbcast:13 row_mask:0xf bank_mask:0xf
    v_mov_b32_dpp v42, v14 row_newbcast:14 row_mask:0xf bank_mask:0xf
    v_mov_b32_dpp v43, v14 row_newbcast:15 row_mask:0xf bank_mask:0xf
    v_mov_b32 v7, 1032
    s_mov_b32 s75, 800000
L_lw_11:
    ds_read_b32 v8, v7
    ds_read_b128 v[64:67], v11 offset:18432
    ds_read_b128 v[68:71], v11 offset:20480
    ds_read_b128 v[72:75], v11 offset:22528
    ds_read_b128 v[76:79], v11 offset:24576
    ds_read_b128 v[80:83], v11 offset:26624
    ds_read_b128 v[84:87], v11 offset:28672
    ds_read_b128 v[88:91], v11 offset:30720
    ds_read_b128 v[92:95], v11 offset:32768
    ds_read_b128 v[96:99], v11 offset:34816
    ds_read_b128 v[100:103], v11 offset:36864
    ds_read_b128 v[104:107], v11 offset:38912
    ds_read_b128 v[108:111], v11 offset:40960
    s_waitcnt lgkmcnt(0)
    v_readfirstlane_b32 s73, v8
    s_cmp_ge_u32 s73, 12
    s_cbranch_scc1 L_lok_12
    s_sub_u32 s75, s75, 1
    s_cmp_eq_u32 s75, 0
    s_cbranch_scc1 L_lok_12
    s_sleep 2
    s_branch L_lw_11
L_lok_12:
    v_pk_mul_f32 v[24:25], v[64:65], v[32:33] op_sel:[0,0] op_sel_hi:[1,0]
    v_pk_mul_f32 v[26:27], v[66:67], v[32:33] op_sel:[0,0] op_sel_hi:[1,0]
    v_pk_fma_f32 v[24:25], v[68:69], v[32:33], v[24:25] op_sel:[0,1,0] op_sel_hi:[1,1,1]
    v_pk_fma_f32 v[26:27], v[70:71], v[32:33], v[26:27] op_sel:[0,1,0] op_sel_hi:[1,1,1]
    v_pk_fma_f32 v[24:25], v[72:73], v[34:35], v[24:25] op_sel:[0,0,0] op_sel_hi:[1,0,1]
    v_pk_fma_f32 v[26:27], v[74:75], v[34:35], v[26:27] op_sel:[0,0,0] op_sel_hi:[1,0,1]
    v_pk_fma_f32 v[24:25], v[76:77], v[34:35], v[24:25] op_sel:[0,1,0] op_sel_hi:[1,1,1]
    v_pk_fma_f32 v[26:27], v[78:79], v[34:35], v[26:27] op_sel:[0,1,0] op_sel_hi:[1,1,1]
    v_pk_fma_f32 v[24:25], v[80:81], v[36:37], v[24:25] op_sel:[0,0,0] op_sel_hi:[1,0,1]
    v_pk_fma_f32 v[26:27], v[82:83], v[36:37], v[26:27] op_sel:[0,0,0] op_sel_hi:[1,0,1]
    v_pk_fma_f32 v[24:25], v[84:85], v[36:37], v[24:25] op_sel:[0,1,0] op_sel_hi:[1,1,1]
    v_pk_fma_f32 v[26:27], v[86:87], v[36:37], v[26:27] op_sel:[0,1,0] op_sel_hi:[1,1,1]
    v_pk_fma_f32 v[24:25], v[88:89], v[38:39], v[24:25] op_sel:[0,0,0] op_sel_hi:[1,0,1]
    v_pk_fma_f32 v[26:27], v[90:91], v[38:39], v[26:27] op_sel:[0,0,0] op_sel_hi:[1,0,1]
    v_pk_fma_f32 v[24:25], v[92:93], v[38:39], v[24:25] op_sel:[0,1,0] op_sel_hi:[1,1,1]
    v_pk_fma_f32 v[26:27], v[94:95], v[38:39], v[26:27] op_sel:[0,1,0] op_sel_hi:[1,1,1]
    v_pk_fma_f32 v[24:25], v[96:97], v[40:41], v[24:25] op_sel:[0,0,0] op_sel_hi:[1,0,1]
    v_pk_fma_f32 v[26:27], v[98:99], v[40:41], v[26:27] op_sel:[0,0,0] op_sel_hi:[1,0,1]
    v_pk_fma_f32 v[24:25], v[100:101], v[40:41], v[24:25] op_sel:[0,1,0] op_sel_hi:[1,1,1]
    v_pk_fma_f32 v[26:27], v[102:103], v[40:41], v[26:27] op_sel:[0,1,0] op_sel_hi:[1,1,1]
    v_pk_fma_f32 v[24:25], v[104:105], v[42:43], v[24:25] op_sel:[0,0,0] op_sel_hi:[1,0,1]
    v_pk_fma_f32 v[26:27], v[106:107], v[42:43], v[26:27] op_sel:[0,0,0] op_sel_hi:[1,0,1]
    v_pk_fma_f32 v[24:25], v[108:109], v[42:43], v[24:25] op_sel:[0,1,0] op_sel_hi:[1,1,1]
    v_pk_fma_f32 v[26:27], v[110:111], v[42:43], v[26:27] op_sel:[0,1,0] op_sel_hi:[1,1,1]
    v_mov_b32 v7, 1036
    s_setprio 2
    s_mov_b32 s75, 800000
L_lw_13:
    ds_read_b32 v8, v7
    ds_read_b128 v[48:51], v11 offset:10240
    ds_read_b128 v[52:55], v11 offset:12288
    ds_read_b128 v[56:59], v11 offset:14336
    ds_read_b128 v[60:63], v11 offset:16384
    s_waitcnt lgkmcnt(0)
    v_readfirstlane_b32 s73, v8
    s_cmp_ge_u32 s73, 4
    s_cbranch_scc1 L_lok_14
    s_sub_u32 s75, s75, 1
    s_cmp_eq_u32 s75, 0
    s_cbranch_scc1 L_lok_14
    s_branch L_lw_13
L_lok_14:
    v_pk_fma_f32 v[24:25], v[48:49], v[28:29], v[24:25] op_sel:[0,0,0] op_sel_hi:[1,0,1]
    v_pk_fma_f32 v[26:27], v[50:51], v[28:29], v[26:27] op_sel:[0,0,0] op_sel_hi:[1,0,1]
    v_pk_fma_f32 v[24:25], v[52:53], v[28:29], v[24:25] op_sel:[0,1,0] op_sel_hi:[1,1,1]
    v_pk_fma_f32 v[26:27], v[54:55], v[28:29], v[26:27] op_sel:[0,1,0] op_sel_hi:[1,1,1]
    v_pk_fma_f32 v[24:25], v[56:57], v[30:31], v[24:25] op_sel:[0,0,0] op_sel_hi:[1,0,1]
    v_pk_fma_f32 v[26:27], v[58:59], v[30:31], v[26:27] op_sel:[0,0,0] op_sel_hi:[1,0,1]
    v_pk_fma_f32 v[24:25], v[60:61], v[30:31], v[24:25] op_sel:[0,1,0] op_sel_hi:[1,1,1]
    v_pk_fma_f32 v[26:27], v[62:63], v[30:31], v[26:27] op_sel:[0,1,0] op_sel_hi:[1,1,1]
    v_bfi_b32 v27, s66, v5, v27
    s_cmp_eq_u32 s68, 2
    s_cbranch_scc0 L_opfar
    buffer_store_dwordx4 v[24:27], v3, s[44:47], s42 offen
    s_branch L_fin
L_opfar:
    buffer_store_dwordx4 v[24:27], v3, s[44:47], s42 offen sc1
    s_branch L_fin
L_wojob:
    s_lshr_b32 s79, s5, 3
    s_and_b32 s43, s3, 1
    v_and_b32 v8, 7, v6
    v_lshlrev_b32 v8, 2, v8
    v_lshrrev_b32 v9, 1, v4
    v_lshrrev_b32 v10, 2, v6
    v_and_b32 v10, 2, v10
    v_xor_b32 v10, v4, v10
    v_add_u32 v8, v8, v10
    v_lshlrev_b32 v8, 6, v8
    v_and_b32 v10, 1, v4
    v_lshlrev_b32 v11, 11, v4
    v_lshl_add_u32 v11, v6, 4, v11
    v_lshlrev_b32 v12, 7, v10
    v_lshl_add_u32 v12, v6, 3, v12
    v_lshl_add_u32 v12, v9, 2, v12
    v_bfe_u32 v13, v1, 2, 1
    v_lshlrev_b32 v13, 7, v13
    v_lshl_add_u32 v13, v4, 4, v13
    s_lshl_b32 s73, s3, 8
    v_add_u32 v12, s73, v12
    v_add_u32 v13, s73, v13
    v_bfe_u32 v14, v1, 3, 1
    v_lshl_add_u32 v13, v14, 6, v13
    v_and_b32 v9, 7, v1
    v_lshlrev_b32 v15, 14, v4
    v_lshl_add_u32 v15, v14, 16, v15
    v_lshl_add_u32 v15, v9, 4, v15
    v_lshlrev_b32 v10, 8, v10
    v_lshl_add_u32 v10, v6, 5, v10
    v_lshrrev_b32 v0, 1, v4
    v_lshl_add_u32 v10, v0, 4, v10
    v_bfe_u32 v0, v10, 4, 2
    v_lshlrev_b32 v0, 3, v0
    s_and_b32 s73, s65, 15
    v_bfe_u32 v0, s65, v0, 8
    v_lshl_or_b32 v0, v0, 4, s73
    s_mov_b32 s52, s24
    s_mov_b32 s53, s25
    s_mov_b32 s54, 0x400000
    s_mov_b32 s55, 0x00020000
    s_lshl_b32 s7, s43, 2
    s_add_u32 s7, s7, s5
    s_add_u32 s7, s7, 3
    s_and_b32 s7, s7, 7
    s_lshl_b32 s48, s4, 19
    s_lshl_b32 s73, s79, 17
    s_add_u32 s48, s48, s73
    s_lshl_b32 s73, s43, 12
    s_add_u32 s48, s48, s73
    s_lshl_b32 s73, s7, 7
    s_add_u32 s48, s48, s73
    s_add_u32 s49, s48, 0x2000
    s_add_u32 s50, s48, 0x10000
    s_add_u32 s51, s48, 0x12000
    s_mul_i32 s7, s7, 0x40000
    s_lshl_b32 s76, s4, 3
    s_lshl_b32 s73, s79, 1
    s_add_u32 s76, s76, s73
    s_add_u32 s76, s76, s43
    s_and_b32 s73, s76, 48
    s_add_u32 s76, s76, s73
    s_lshl_b32 s76, s76, 9
    s_add_u32 s76, s76, s7
    s_add_u32 s76, s76, 0x20000
    s_lshl_b32 s73, s79, 4
    s_add_u32 s6, s78, s73
    s_add_u32 s6, s6, 0x800
    s_lshl_b32 s73, s43, 10
    s_add_u32 s42, s78, s73
    s_lshl_b32 s73, s79, 8
    s_add_u32 s42, s42, s73
    s_add_u32 s56, s42, 0x10000
    s_add_u32 s57, s42, 0x12000
    s_add_u32 s58, s42, 0x14000
    s_add_u32 s59, s42, 0x16000
    s_add_u32 s60, s42, 0x18000
    s_add_u32 s61, s42, 0x1a000
    s_add_u32 s62, s42, 0x1c000
    s_add_u32 s63, s42, 0x1e000
    s_mov_b64 exec, 0xff
    v_and_b32 v9, 3, v1
    v_lshlrev_b32 v9, 7, v9
    v_and_b32 v14, 4, v1
    v_lshl_add_u32 v9, v14, 11, v9
    buffer_load_dword v125, v9, s[44:47], s76 offen sc1
    s_mov_b64 exec, -1
    v_mov_b32 v7, 1052
    s_mov_b32 s75, 800000
L_lw_15:
    ds_read_b32 v9, v7
    s_waitcnt lgkmcnt(0)
    v_readfirstlane_b32 s73, v9
    s_cmp_ge_u32 s73, 4
    s_cbranch_scc1 L_lok_16
    s_sub_u32 s75, s75, 1
    s_cmp_eq_u32 s75, 0
    s_cbranch_scc1 L_lok_16
    s_sleep 2
    s_branch L_lw_15
L_lok_16:
    buffer_load_dwordx4 v[120:123], v8, s[44:47], s6 offen sc1
    v_mov_b32 v7, 1100
    s_mov_b32 s75, 800000
L_lw_17:
    ds_read_b32 v9, v7
    s_waitcnt lgkmcnt(0)
    v_readfirstlane_b32 s73, v9
    s_cmp_ge_u32 s73, 2
    s_cbranch_scc1 L_lok_18
    s_sub_u32 s75, s75, 1
    s_cmp_eq_u32 s75, 0
    s_cbranch_scc1 L_lok_18
    s_sleep 1
    s_branch L_lw_17
L_lok_18:
    buffer_load_dwordx4 v[48:51], v15, s[52:55], s48 offen offset:0 nt
    buffer_load_dwordx4 v[52:55], v15, s[52:55], s48 offen offset:1024 nt
    buffer_load_dwordx4 v[56:59], v15, s[52:55], s48 offen offset:2048 nt
    buffer_load_dwordx4 v[60:63], v15, s[52:55], s48 offen offset:3072 nt
    buffer_load_dwordx4 v[64:67], v15, s[52:55], s49 offen offset:0 nt
    buffer_load_dwordx4 v[68:71], v15, s[52:55], s49 offen offset:1024 nt
    buffer_load_dwordx4 v[72:75], v15, s[52:55], s49 offen offset:2048 nt
    buffer_load_dwordx4 v[76:79], v15, s[52:55], s49 offen offset:3072 nt
    s_mov_b32 s7, 0
    s_waitcnt vmcnt(8)
    v_cmp_ne_u32 vcc, s65, v123
    s_cbranch_vccnz L_wperm
L_wfac:
    v_mov_b32 v124, v120
    s_nop 1
    v_max_f32_dpp v124, v124, v124 row_ror:8 row_mask:0xf bank_mask:0xf
    s_nop 1
    v_max_f32_dpp v124, v124, v124 row_ror:4 row_mask:0xf bank_mask:0xf
    s_nop 1
    v_max_f32_dpp v124, v124, v124 row_ror:2 row_mask:0xf bank_mask:0xf
    s_nop 1
    v_max_f32_dpp v124, v124, v124 row_ror:1 row_mask:0xf bank_mask:0xf
    v_sub_f32 v120, v120, v124
    v_exp_f32 v120, v120
    s_nop 0
    v_mul_f32 v121, v120, v121
    s_nop 1
    v_add_f32_dpp v121, v121, v121 row_ror:8 row_mask:0xf bank_mask:0xf
    s_nop 1
    v_add_f32_dpp v121, v121, v121 row_ror:4 row_mask:0xf bank_mask:0xf
    s_nop 1
    v_add_f32_dpp v121, v121, v121 row_ror:2 row_mask:0xf bank_mask:0xf
    s_nop 1
    v_add_f32_dpp v121, v121, v121 row_ror:1 row_mask:0xf bank_mask:0xf
    v_rcp_f32 v121, v121
    s_nop 0
    v_mul_f32 v14, v120, v121
    s_nop 1
    v_mov_b32_dpp v112, v14 row_newbcast:0 row_mask:0xf bank_mask:0xf
    v_mov_b32_dpp v113, v14 row_newbcast:1 row_mask:0xf bank_mask:0xf
    v_mov_b32_dpp v114, v14 row_newbcast:2 row_mask:0xf bank_mask:0xf
    v_mov_b32_dpp v115, v14 row_newbcast:3 row_mask:0xf bank_mask:0xf
    v_mov_b32_dpp v116, v14 row_newbcast:4 row_mask:0xf bank_mask:0xf
    v_mov_b32_dpp v117, v14 row_newbcast:5 row_mask:0xf bank_mask:0xf
    v_mov_b32_dpp v118, v14 row_newbcast:6 row_mask:0xf bank_mask:0xf
    v_mov_b32_dpp v119, v14 row_newbcast:7 row_mask:0xf bank_mask:0xf
    s_cmp_eq_u32 s7, 2
    s_mov_b32 s7, 1
    s_cbranch_scc1 L_wchk2
L_wperm:
    s_waitcnt vmcnt(0)
    s_setprio 2
    s_cmp_eq_u32 s7, 1
    s_cbranch_scc1 L_nml_19
    buffer_load_dwordx4 v[120:123], v8, s[44:47], s6 offen sc1
L_nml_19:
    buffer_load_dwordx4 v[16:19], v11, s[44:47], s56 offen sc1
    buffer_load_dwordx4 v[20:23], v11, s[44:47], s57 offen sc1
    buffer_load_dwordx4 v[24:27], v11, s[44:47], s58 offen sc1
    buffer_load_dwordx4 v[28:31], v11, s[44:47], s59 offen sc1
    buffer_load_dwordx4 v[32:35], v11, s[44:47], s60 offen sc1
    buffer_load_dwordx4 v[36:39], v11, s[44:47], s61 offen sc1
    buffer_load_dwordx4 v[40:43], v11, s[44:47], s62 offen sc1
    buffer_load_dwordx4 v[44:47], v11, s[44:47], s63 offen sc1
    v_perm_b32 v80, v52, v48, s69
    v_perm_b32 v84, v52, v48, s70
    v_perm_b32 v81, v60, v56, s69
    v_perm_b32 v85, v60, v56, s70
    v_perm_b32 v82, v68, v64, s69
    v_perm_b32 v86, v68, v64, s70
    v_perm_b32 v83, v76, v72, s69
    v_perm_b32 v87, v76, v72, s70
    v_perm_b32 v88, v53, v49, s69
    v_perm_b32 v92, v53, v49, s70
    v_perm_b32 v89, v61, v57, s69
    v_perm_b32 v93, v61, v57, s70
    v_perm_b32 v90, v69, v65, s69
    v_perm_b32 v94, v69, v65, s70
    v_perm_b32 v91, v77, v73, s69
    v_perm_b32 v95, v77, v73, s70
    v_perm_b32 v96, v54, v50, s69
    v_perm_b32 v100, v54, v50, s70
    v_perm_b32 v97, v62, v58, s69
    v_perm_b32 v101, v62, v58, s70
    v_perm_b32 v98, v70, v66, s69
    v_perm_b32 v102, v70, v66, s70
    v_perm_b32 v99, v78, v74, s69
    v_perm_b32 v103, v78, v74, s70
    v_perm_b32 v104, v55, v51, s69
    v_perm_b32 v108, v55, v51, s70
    v_perm_b32 v105, v63, v59, s69
    v_perm_b32 v109, v63, v59, s70
    v_perm_b32 v106, v71, v67, s69
    v_perm_b32 v110, v71, v67, s70
    v_perm_b32 v107, v79, v75, s69
    v_perm_b32 v111, v79, v75, s70
    s_mov_b32 s75, 200000
    s_branch L_wchk
L_wpoll2:
    s_cmp_eq_u32 s7, 1
    s_cbranch_scc1 L_nml_20
    buffer_load_dwordx4 v[120:123], v8, s[44:47], s6 offen sc1
L_nml_20:
    buffer_load_dwordx4 v[16:19], v11, s[44:47], s56 offen sc1
    buffer_load_dwordx4 v[20:23], v11, s[44:47], s57 offen sc1
    buffer_load_dwordx4 v[24:27], v11, s[44:47], s58 offen sc1
    buffer_load_dwordx4 v[28:31], v11, s[44:47], s59 offen sc1
    buffer_load_dwordx4 v[32:35], v11, s[44:47], s60 offen sc1
    buffer_load_dwordx4 v[36:39], v11, s[44:47], s61 offen sc1
    buffer_load_dwordx4 v[40:43], v11, s[44:47], s62 offen sc1
    buffer_load_dwordx4 v[44:47], v11, s[44:47], s63 offen sc1
L_wchk:
    s_cmp_eq_u32 s7, 1
    s_cbranch_scc1 L_wchk2
    s_waitcnt vmcnt(8)
    v_cmp_ne_u32 vcc, s65, v123
    s_mov_b32 s7, 2
    s_cbranch_vccz L_wfac
    s_mov_b32 s7, 0
    s_waitcnt vmcnt(0)
    s_branch L_wretry
L_wchk2:
    s_waitcnt vmcnt(7)
    v_xor_b32 v19, v5, v19
    v_pk_mul_f32 v[48:49], v[16:17], v[112:113] op_sel:[0,0] op_sel_hi:[1,0]
    v_pk_mul_f32 v[50:51], v[18:19], v[112:113] op_sel:[0,0] op_sel_hi:[1,0]
    s_waitcnt vmcnt(6)
    v_xor_b32 v23, v5, v23
    v_pk_fma_f32 v[48:49], v[20:21], v[112:113], v[48:49] op_sel:[0,1,0] op_sel_hi:[1,1,1]
    v_pk_fma_f32 v[50:51], v[22:23], v[112:113], v[50:51] op_sel:[0,1,0] op_sel_hi:[1,1,1]
    v_or_b32 v14, v19, v23
    s_waitcnt vmcnt(5)
    v_xor_b32 v27, v5, v27
    v_pk_fma_f32 v[48:49], v[24:25], v[114:115], v[48:49] op_sel:[0,0,0] op_sel_hi:[1,0,1]
    v_pk_fma_f32 v[50:51], v[26:27], v[114:115], v[50:51] op_sel:[0,0,0] op_sel_hi:[1,0,1]
    s_waitcnt vmcnt(4)
    v_xor_b32 v31, v5, v31
    v_pk_fma_f32 v[48:49], v[28:29], v[114:115], v[48:49] op_sel:[0,1,0] op_sel_hi:[1,1,1]
    v_pk_fma_f32 v[50:51], v[30:31], v[114:115], v[50:51] op_sel:[0,1,0] op_sel_hi:[1,1,1]
    v_or3_b32 v14, v14, v27, v31
    s_waitcnt vmcnt(3)
    v_xor_b32 v35, v5, v35
    v_pk_fma_f32 v[48:49], v[32:33], v[116:117], v[48:49] op_sel:[0,0,0] op_sel_hi:[1,0,1]
    v_pk_fma_f32 v[50:51], v[34:35], v[116:117], v[50:51] op_sel:[0,0,0] op_sel_hi:[1,0,1]
    s_waitcnt vmcnt(2)
    v_xor_b32 v39, v5, v39
    v_pk_fma_f32 v[48:49], v[36:37], v[116:117], v[48:49] op_sel:[0,1,0] op_sel_hi:[1,1,1]
    v_pk_fma_f32 v[50:51], v[38:39], v[116:117], v[50:51] op_sel:[0,1,0] op_sel_hi:[1,1,1]
    v_or3_b32 v14, v14, v35, v39
    s_waitcnt vmcnt(1)
    v_xor_b32 v43, v5, v43
    v_pk_fma_f32 v[48:49], v[40:41], v[118:119], v[48:49] op_sel:[0,0,0] op_sel_hi:[1,0,1]
    v_pk_fma_f32 v[50:51], v[42:43], v[118:119], v[50:51] op_sel:[0,0,0] op_sel_hi:[1,0,1]
    s_waitcnt vmcnt(0)
    v_xor_b32 v47, v5, v47
    v_pk_fma_f32 v[48:49], v[44:45], v[118:119], v[48:49] op_sel:[0,1,0] op_sel_hi:[1,1,1]
    v_pk_fma_f32 v[50:51], v[46:47], v[118:119], v[50:51] op_sel:[0,1,0] op_sel_hi:[1,1,1]
    v_or3_b32 v14, v14, v43, v47
    v_and_b32 v14, s66, v14
    v_cmp_ne_u32 vcc, 0, v14
    s_cbranch_vccz L_wok
L_wretry:
    s_sub_u32 s75, s75, 1
    s_cmp_lg_u32 s75, 0
    s_cbranch_scc1 L_wpoll2
L_wok:
    v_permlane32_swap_b32 v48, v50
    v_permlane32_swap_b32 v49, v51
    v_add_f32 v48, v48, v50
    v_add_f32 v49, v49, v51
    v_cvt_pk_bf16_f32 v48, v48, v49
    ds_write_b32 v12, v48 offset:6144
    ds_read_b128 v[52:55], v13 offset:6144
    s_waitcnt lgkmcnt(0)
    v_mfma_f32_16x16x32_bf16 v[16:19], v[52:55], v[80:83], 0
    v_mfma_f32_16x16x32_bf16 v[32:35], v[52:55], v[96:99], 0
    v_mfma_f32_16x16x32_bf16 v[20:23], v[52:55], v[84:87], 0
    v_mfma_f32_16x16x32_bf16 v[36:39], v[52:55], v[100:103], 0
    v_mfma_f32_16x16x32_bf16 v[24:27], v[52:55], v[88:91], 0
    v_mfma_f32_16x16x32_bf16 v[40:43], v[52:55], v[104:107], 0
    v_mfma_f32_16x16x32_bf16 v[28:31], v[52:55], v[92:95], 0
    v_mfma_f32_16x16x32_bf16 v[44:47], v[52:55], v[108:111], 0
    s_nop 0
    v_mov_b32_dpp v16, v17 row_ror:8 row_mask:0xc bank_mask:0xf
    v_mov_b32_dpp v32, v33 row_ror:8 row_mask:0xc bank_mask:0xf
    v_mov_b32_dpp v20, v21 row_ror:8 row_mask:0xc bank_mask:0xf
    v_mov_b32_dpp v36, v37 row_ror:8 row_mask:0xc bank_mask:0xf
    v_mov_b32_dpp v24, v25 row_ror:8 row_mask:0xc bank_mask:0xf
    v_mov_b32_dpp v40, v41 row_ror:8 row_mask:0xc bank_mask:0xf
    v_mov_b32_dpp v28, v29 row_ror:8 row_mask:0xc bank_mask:0xf
    v_mov_b32_dpp v44, v45 row_ror:8 row_mask:0xc bank_mask:0xf
    v_permlane32_swap_b32 v16, v32
    v_permlane32_swap_b32 v20, v36
    v_permlane32_swap_b32 v24, v40
    v_permlane32_swap_b32 v28, v44
    v_add_f32 v56, v16, v32
    v_add_f32 v57, v20, v36
    v_add_f32 v58, v24, v40
    v_add_f32 v59, v28, v44
    v_bfi_b32 v59, s66, v0, v59
    s_mov_b32 exec_lo, 0x00ff00ff
    s_mov_b32 exec_hi, 0x00ff00ff
    buffer_store_dwordx4 v[56:59], v10, s[44:47], s76 offen sc1
    s_xor_b32 s76, s76, 0x2000
    buffer_store_dwordx4 v[56:59], v10, s[44:47], s76 offen sc1
    s_mov_b64 exec, -1
    v_mov_b32 v7, 1060
    v_mov_b32 v9, 1
    s_mov_b64 exec, 1
    ds_add_u32 v7, v9
    s_mov_b64 exec, -1
L_fin:
L_end:
    s_endpgm
L_svcmid:
    s_cmp_eq_u32 s62, 0
    s_cbranch_scc1 L_svcmid2
    s_cmp_eq_u32 s62, 1
    s_cbranch_scc1 L_bjob
    s_cmp_eq_u32 s68, 2
    s_cbranch_scc1 L_svcmid2
    s_mov_b32 exec_lo, 0x00ff00ff
    s_mov_b32 exec_hi, 0x00ff00ff
    buffer_store_dwordx4 v[48:51], v52, s[44:47], s6 offen sc1
    s_mov_b64 exec, -1
    s_branch L_svcmid2
L_bjob:
    s_lshl_b32 s73, s7, 12
    s_add_u32 s42, s78, s73
    s_add_u32 s42, s42, 0x8000
    s_mov_b32 s75, 200000
L_poll_21:
    buffer_load_dwordx4 v[16:19], v3, s[44:47], s42 offen offset:0 sc1
    buffer_load_dwordx4 v[20:23], v3, s[44:47], s42 offen offset:1024 sc1
    buffer_load_dwordx4 v[24:27], v3, s[44:47], s42 offen offset:2048 sc1
    buffer_load_dwordx4 v[28:31], v3, s[44:47], s42 offen offset:3072 sc1
    s_waitcnt vmcnt(0)
    v_xor_b32 v19, v5, v19
    v_xor_b32 v23, v5, v23
    v_xor_b32 v27, v5, v27
    v_xor_b32 v31, v5, v31
    v_or3_b32 v10, v19, v23, v27
    v_or_b32 v10, v10, v31
    v_and_b32 v10, s66, v10
    v_cmp_ne_u32 vcc, 0, v10
    s_cbranch_vccz L_pok_22
    s_sub_u32 s75, s75, 1
    s_cmp_eq_u32 s75, 0
    s_cbranch_scc1 L_pok_22
    s_sleep 8
    s_branch L_poll_21
L_pok_22:
    v_add_f32 v16, v16, v20
    v_add_f32 v24, v24, v28
    v_add_f32 v17, v17, v21
    v_add_f32 v25, v25, v29
    v_add_f32 v18, v18, v22
    v_add_f32 v26, v26, v30
    v_add_f32 v19, v19, v23
    v_add_f32 v27, v27, v31
    v_permlane32_swap_b32 v16, v18
    v_permlane32_swap_b32 v17, v19
    v_permlane32_swap_b32 v24, v26
    v_permlane32_swap_b32 v25, v27
    v_add_f32 v16, v16, v18
    v_add_f32 v17, v17, v19
    v_add_f32 v18, v24, v26
    v_add_f32 v19, v25, v27
    v_cvt_pk_bf16_f32 v16, v16, v16
    v_cvt_pk_bf16_f32 v17, v17, v17
    v_cvt_pk_bf16_f32 v18, v18, v18
    v_cvt_pk_bf16_f32 v19, v19, v19
    v_and_b32 v16, s77, v16
    v_and_b32 v17, s77, v17
    v_and_b32 v18, s77, v18
    v_and_b32 v19, s77, v19
    v_lshlrev_b32 v20, 16, v14
    v_and_b32 v21, s77, v14
    v_lshlrev_b32 v22, 16, v15
    v_and_b32 v23, s77, v15
    v_add_f32 v16, v16, v20
    v_add_f32 v17, v17, v21
    v_add_f32 v18, v18, v22
    v_add_f32 v19, v19, v23
    v_cvt_pk_bf16_f32 v16, v16, v16
    v_cvt_pk_bf16_f32 v17, v17, v17
    v_cvt_pk_bf16_f32 v18, v18, v18
    v_cvt_pk_bf16_f32 v19, v19, v19
    v_and_b32 v16, s77, v16
    v_and_b32 v17, s77, v17
    v_and_b32 v18, s77, v18
    v_and_b32 v19, s77, v19
    s_mov_b32 s73, 0x3d372713
    v_mul_f32 v20, v16, v16
    v_mul_f32 v21, v17, v17
    v_mul_f32 v22, v18, v18
    v_mul_f32 v23, v19, v19
    v_fma_f32 v20, v20, s73, 1.0
    v_fma_f32 v21, v21, s73, 1.0
    v_fma_f32 v22, v22, s73, 1.0
    v_fma_f32 v23, v23, s73, 1.0
    v_mul_f32 v20, v20, v16
    v_mul_f32 v21, v21, v17
    v_mul_f32 v22, v22, v18
    v_mul_f32 v23, v23, v19
    v_mul_f32 v20, 0xc0135761, v20
    v_mul_f32 v21, 0xc0135761, v21
    v_mul_f32 v22, 0xc0135761, v22
    v_mul_f32 v23, 0xc0135761, v23
    v_exp_f32 v20, v20
    v_exp_f32 v21, v21
    v_exp_f32 v22, v22
    v_exp_f32 v23, v23
    v_add_f32 v20, 1.0, v20
    v_add_f32 v21, 1.0, v21
    v_add_f32 v22, 1.0, v22
    v_add_f32 v23, 1.0, v23
    v_rcp_f32 v20, v20
    v_rcp_f32 v21, v21
    v_rcp_f32 v22, v22
    v_rcp_f32 v23, v23
    v_mul_f32 v16, v16, v20
    v_mul_f32 v17, v17, v21
    v_mul_f32 v18, v18, v22
    v_mul_f32 v19, v19, v23
    v_cvt_pk_bf16_f32 v16, v16, v17
    v_cvt_pk_bf16_f32 v17, v18, v19
    v_and_b32 v10, 1, v4
    v_lshl_add_u32 v10, v10, 8, v13
    ds_write_b32 v10, v16 offset:6144
    ds_write_b32 v10, v17 offset:6272
    s_waitcnt vmcnt(0)
    ds_read_b128 v[48:51], v3 offset:43008
    ds_read_b128 v[52:55], v3 offset:44032
    ds_read_b128 v[56:59], v3 offset:45056
    ds_read_b128 v[60:63], v3 offset:46080
    ds_read_b128 v[64:67], v3 offset:47104
    ds_read_b128 v[68:71], v3 offset:48128
    ds_read_b128 v[72:75], v3 offset:49152
    ds_read_b128 v[76:79], v3 offset:50176
    ds_read_b128 v[80:83], v3 offset:51200
    ds_read_b128 v[84:87], v3 offset:52224
    ds_read_b128 v[88:91], v3 offset:53248
    ds_read_b128 v[92:95], v3 offset:54272
    ds_read_b128 v[96:99], v3 offset:55296
    ds_read_b128 v[100:103], v3 offset:56320
    ds_read_b128 v[104:107], v3 offset:57344
    ds_read_b128 v[108:111], v3 offset:58368
    s_movk_i32 s61, 4096
    v_bfe_u32 v7, v1, 2, 1
    v_lshlrev_b32 v7, 8, v7
    s_waitcnt lgkmcnt(0)
    s_branch L_gemv2
L_svcmid2:
    v_mov_b32 v9, 1
    s_cmp_lg_u32 s3, 0
    s_cbranch_scc1 L_noml0
    v_mov_b32 v7, 1028
    v_lshlrev_b32 v10, 5, v6
    v_lshl_add_u32 v10, v4, 3, v10
    s_lshl_b32 s42, s5, 6
    s_add_u32 s42, s42, s78
    s_add_u32 s42, s42, 0x800
    v_mov_b32 v22, 0
    v_mov_b32 v23, s65
    s_mov_b32 s75, 800000
L_lw_23:
    ds_read_b32 v8, v7
    ds_read_b64 v[16:17], v10 offset:1536
    s_waitcnt lgkmcnt(0)
    v_readfirstlane_b32 s73, v8
    s_cmp_ge_u32 s73, 16
    s_cbranch_scc1 L_lok_24
    s_sub_u32 s75, s75, 1
    s_cmp_eq_u32 s75, 0
    s_cbranch_scc1 L_lok_24
    s_sleep 1
    s_branch L_lw_23
L_lok_24:
    s_setprio 3
    v_mov_b32 v20, v16
    s_nop 1
    v_max_f32_dpp v20, v20, v20 row_ror:8 row_mask:0xf bank_mask:0xf
    s_nop 1
    v_max_f32_dpp v20, v20, v20 row_ror:4 row_mask:0xf bank_mask:0xf
    s_nop 1
    v_max_f32_dpp v20, v20, v20 row_ror:2 row_mask:0xf bank_mask:0xf
    s_nop 1
    v_max_f32_dpp v20, v20, v20 row_ror:1 row_mask:0xf bank_mask:0xf
    v_sub_f32 v16, v16, v20
    v_exp_f32 v16, v16
    s_nop 0
    v_mul_f32 v21, v16, v17
    s_nop 1
    v_add_f32_dpp v21, v21, v21 row_ror:8 row_mask:0xf bank_mask:0xf
    s_nop 1
    v_add_f32_dpp v21, v21, v21 row_ror:4 row_mask:0xf bank_mask:0xf
    s_nop 1
    v_add_f32_dpp v21, v21, v21 row_ror:2 row_mask:0xf bank_mask:0xf
    s_nop 1
    v_add_f32_dpp v21, v21, v21 row_ror:1 row_mask:0xf bank_mask:0xf
    s_mov_b32 exec_lo, 0x10001
    s_mov_b32 exec_hi, 0x10001
    s_cmp_eq_u32 s68, 2
    s_cbranch_scc0 L_ml0far
    buffer_store_dwordx4 v[20:23], v1, s[44:47], s42 offen
    s_branch L_ml0done
L_ml0far:
    buffer_store_dwordx4 v[20:23], v1, s[44:47], s42 offen sc1
L_ml0done:
    v_mov_b32 v7, 1040
    v_mov_b32 v8, 16
    s_mov_b64 exec, 1
    ds_add_u32 v7, v8
    s_mov_b64 exec, -1
L_noml0:
L_noml:
    s_mov_b32 s42, 0x1c1c1b1a
    s_lshl_b32 s73, s3, 3
    s_lshr_b32 s42, s42, s73
    s_and_b32 s42, s42, 0xff
    v_mov_b32 v7, 1040
    s_mov_b32 s75, 800000
L_lw_25:
    ds_read_b32 v8, v7
    s_waitcnt lgkmcnt(0)
    v_readfirstlane_b32 s73, v8
    s_cmp_ge_u32 s73, s42
    s_cbranch_scc1 L_lok_26
    s_sub_u32 s75, s75, 1
    s_cmp_eq_u32 s75, 0
    s_cbranch_scc1 L_lok_26
    s_sleep 1
    s_branch L_lw_25
L_lok_26:
    s_setprio 1
    buffer_load_dwordx4 v[48:51], v3, s[12:15], s96 offen offset:0 nt
    buffer_load_dwordx4 v[52:55], v3, s[12:15], s96 offen offset:1024 nt
    buffer_load_dwordx4 v[56:59], v3, s[12:15], s97 offen offset:0 nt
    buffer_load_dwordx4 v[60:63], v3, s[12:15], s97 offen offset:1024 nt
    buffer_load_dwordx4 v[64:67], v3, s[12:15], s98 offen offset:0 nt
    buffer_load_dwordx4 v[68:71], v3, s[12:15], s98 offen offset:1024 nt
    buffer_load_dwordx4 v[72:75], v3, s[12:15], s99 offen offset:0 nt
    buffer_load_dwordx4 v[76:79], v3, s[12:15], s99 offen offset:1024 nt
    s_setprio 3
    v_mov_b32 v8, 1052
    s_mov_b64 exec, 1
    ds_add_u32 v8, v9
    s_mov_b64 exec, -1
    v_mov_b32 v8, 1036
    s_branch L_pphase
L_svc:
    v_lshlrev_b32 v6, 2, v1
    v_mov_b32 v7, 0
    ds_write_b32 v6, v7 offset:1024
    s_and_b32 s4, s2, 7
    s_lshr_b32 s5, s2, 3
    v_lshlrev_b32 v3, 4, v1
    v_and_b32 v6, 15, v1
    s_lshl_b32 s76, s3, 2
    s_add_u32 s76, s76, 48
    s_mov_b32 s62, 0
    s_mov_b32 s63, 0
    v_mov_b32 v52, 0
    v_bfe_u32 v7, v1, 3, 1
    v_lshl_add_u32 v7, v7, 2, v4
    v_and_b32 v0, 7, v1
    s_cmp_ge_u32 s3, 2
    s_cbranch_scc1 L_svc2
    s_cmp_eq_u32 s3, 1
    s_cbranch_scc1 L_w1
    s_mov_b32 s54, 0x400000
    s_movk_i32 s43, 0x2000
    s_mov_b32 s63, 1
    s_lshr_b32 s79, s5, 3
    s_and_b32 s73, s5, 7
    s_lshl_b32 s73, s73, 7
    s_lshl_b32 s68, s4, 10
    s_add_u32 s68, s68, s73
    s_mul_i32 s6, s4, 0x40000
    s_lshl_b32 s73, s5, 9
    s_add_u32 s6, s6, s73
    s_add_u32 s6, s6, 0x34000
    s_waitcnt lgkmcnt(0)
    s_mov_b32 s52, s22
    s_mov_b32 s53, s23
    s_branch L_gemv
L_w1:
    s_bitcmp1_b32 s5, 3
    s_cselect_b32 s7, 2, 0
    s_lshr_b32 s73, s5, 4
    s_add_u32 s7, s7, s73
    s_lshl_b32 s73, s4, 2
    s_lshr_b32 s79, 0x4020404, s73
    s_and_b32 s79, s79, 15
    s_cmp_ge_u32 s7, s79
    s_cbranch_scc1 L_svc2
    s_lshr_b32 s79, 0xeaa88440, s73
    s_and_b32 s79, s79, 15
    s_add_u32 s79, s79, s7
    s_mov_b32 s54, 0x1c0000
    s_movk_i32 s43, 3584
    s_mov_b32 s63, 2
    s_lshl_b32 s68, s79, 8
    s_and_b32 s73, s5, 4
    s_lshl_b32 s73, s73, 5
    s_add_u32 s68, s68, s73
    s_and_b32 s79, s5, 3
    s_mul_i32 s6, s4, 0x40000
    s_lshl_b32 s73, s7, 12
    s_add_u32 s6, s6, s73
    s_and_b32 s73, s5, 7
    s_lshl_b32 s73, s73, 9
    s_add_u32 s6, s6, s73
    s_add_u32 s6, s6, 0x8000
    s_waitcnt lgkmcnt(0)
    s_mov_b32 s52, s28
    s_mov_b32 s53, s29
L_gemv:
    s_mov_b32 s48, s16
    s_mov_b32 s49, s17
    s_mov_b32 s50, 0x800
    s_mov_b32 s51, 0x00020000
    buffer_load_dwordx4 v[8:11], v3, s[48:51], 0 offen
    buffer_load_dwordx4 v[12:15], v3, s[48:51], 0 offen offset:1024
    s_mov_b32 s55, 0x00020000
    s_lshl_b32 s73, s43, 3
    v_mul_u32_u24 v7, s73, v7
    v_lshl_add_u32 v7, v0, 4, v7
    s_lshl_b32 s73, s43, 7
    s_mul_i32 s73, s73, s79
    s_add_u32 s42, s68, s73
    s_mul_i32 s60, s43, 57
    buffer_load_dwordx4 v[48:51], v7, s[52:55], s42 offen nt
    s_add_u32 s42, s42, s43
    buffer_load_dwordx4 v[52:55], v7, s[52:55], s42 offen nt
    s_add_u32 s42, s42, s43
    buffer_load_dwordx4 v[56:59], v7, s[52:55], s42 offen nt
    s_add_u32 s42, s42, s43
    buffer_load_dwordx4 v[60:63], v7, s[52:55], s42 offen nt
    s_add_u32 s42, s42, s43
    buffer_load_dwordx4 v[64:67], v7, s[52:55], s42 offen nt
    s_add_u32 s42, s42, s43
    buffer_load_dwordx4 v[68:71], v7, s[52:55], s42 offen nt
    s_add_u32 s42, s42, s43
    buffer_load_dwordx4 v[72:75], v7, s[52:55], s42 offen nt
    s_add_u32 s42, s42, s43
    buffer_load_dwordx4 v[76:79], v7, s[52:55], s42 offen nt
    s_add_u32 s42, s42, s60
    buffer_load_dwordx4 v[80:83], v7, s[52:55], s42 offen nt
    s_add_u32 s42, s42, s43
    buffer_load_dwordx4 v[84:87], v7, s[52:55], s42 offen nt
    s_add_u32 s42, s42, s43
    buffer_load_dwordx4 v[88:91], v7, s[52:55], s42 offen nt
    s_add_u32 s42, s42, s43
    buffer_load_dwordx4 v[92:95], v7, s[52:55], s42 offen nt
    s_add_u32 s42, s42, s43
    buffer_load_dwordx4 v[96:99], v7, s[52:55], s42 offen nt
    s_add_u32 s42, s42, s43
    buffer_load_dwordx4 v[100:103], v7, s[52:55], s42 offen nt
    s_add_u32 s42, s42, s43
    buffer_load_dwordx4 v[104:107], v7, s[52:55], s42 offen nt
    s_add_u32 s42, s42, s43
    buffer_load_dwordx4 v[108:111], v7, s[52:55], s42 offen nt
L_svc2:
    s_waitcnt lgkmcnt(0)
    s_mov_b32 s8, s18
    s_mov_b32 s9, s19
    s_barrier
    s_and_b32 s73, s76, 15
    s_lshl_b32 s73, s73, 11
    s_lshr_b32 s42, s76, 4
    s_lshl_b32 s42, s42, 19
    s_or_b32 s73, s73, s42
    s_xor_b32 s96, s75, s73
    s_add_u32 s76, s76, 1
    s_and_b32 s73, s76, 15
    s_lshl_b32 s73, s73, 11
    s_lshr_b32 s42, s76, 4
    s_lshl_b32 s42, s42, 19
    s_or_b32 s73, s73, s42
    s_xor_b32 s97, s75, s73
    s_add_u32 s76, s76, 1
    s_and_b32 s73, s76, 15
    s_lshl_b32 s73, s73, 11
    s_lshr_b32 s42, s76, 4
    s_lshl_b32 s42, s42, 19
    s_or_b32 s73, s73, s42
    s_xor_b32 s98, s75, s73
    s_add_u32 s76, s76, 1
    s_and_b32 s73, s76, 15
    s_lshl_b32 s73, s73, 11
    s_lshr_b32 s42, s76, 4
    s_lshl_b32 s42, s42, 19
    s_or_b32 s73, s73, s42
    s_xor_b32 s99, s75, s73
    s_waitcnt lgkmcnt(0)
    s_load_dword s64, s[40:41], 0
    s_mov_b32 s12, s20
    s_mov_b32 s13, s21
    s_mov_b32 s14, 0x2000000
    s_mov_b32 s15, 0x00020000
    s_mov_b32 s44, s40
    s_mov_b32 s45, s41
    s_mov_b32 s46, 0x10000000
    s_mov_b32 s47, 0x00020000
    s_mov_b32 s69, 0x05040100
    s_mov_b32 s70, 0x07060302
    s_mov_b32 s71, 0x3e0293ee
    s_mov_b32 s77, 0xffff0000
    s_movk_i32 s66, 0xfff
    s_mul_i32 s78, s4, 0x40000
    s_getreg_b32 s67, hwreg(HW_REG_XCC_ID, 0, 4)
    s_cmp_eq_u32 s63, 0
    s_cbranch_scc1 L_wk
    s_lshl_b32 s61, s3, 11
    v_add_u32 v0, s61, v3
    s_waitcnt vmcnt(16)
L_ln:
    v_lshlrev_b32 v16, 16, v8
    v_and_b32 v17, s77, v8
    v_lshlrev_b32 v18, 16, v9
    v_and_b32 v19, s77, v9
    v_lshlrev_b32 v20, 16, v10
    v_and_b32 v21, s77, v10
    v_lshlrev_b32 v22, 16, v11
    v_and_b32 v23, s77, v11
    v_lshlrev_b32 v24, 16, v12
    v_and_b32 v25, s77, v12
    v_lshlrev_b32 v26, 16, v13
    v_and_b32 v27, s77, v13
    v_lshlrev_b32 v28, 16, v14
    v_and_b32 v29, s77, v14
    v_lshlrev_b32 v30, 16, v15
    v_and_b32 v31, s77, v15
    v_add_f32 v32, v16, v17
    v_add_f32 v32, v32, v18
    v_add_f32 v32, v32, v19
    v_add_f32 v32, v32, v20
    v_add_f32 v32, v32, v21
    v_add_f32 v32, v32, v22
    v_add_f32 v32, v32, v23
    v_add_f32 v33, v24, v25
    v_add_f32 v33, v33, v26
    v_add_f32 v33, v33, v27
    v_add_f32 v33, v33, v28
    v_add_f32 v33, v33, v29
    v_add_f32 v33, v33, v30
    v_add_f32 v33, v33, v31
    v_add_f32_dpp v32, v32, v32 row_ror:8 row_mask:0xf bank_mask:0xf
    s_nop 0
    v_add_f32_dpp v33, v33, v33 row_ror:8 row_mask:0xf bank_mask:0xf
    v_add_f32_dpp v32, v32, v32 row_ror:4 row_mask:0xf bank_mask:0xf
    s_nop 0
    v_add_f32_dpp v33, v33, v33 row_ror:4 row_mask:0xf bank_mask:0xf
    v_add_f32_dpp v32, v32, v32 row_ror:2 row_mask:0xf bank_mask:0xf
    s_nop 0
    v_add_f32_dpp v33, v33, v33 row_ror:2 row_mask:0xf bank_mask:0xf
    v_add_f32_dpp v32, v32, v32 row_ror:1 row_mask:0xf bank_mask:0xf
    s_nop 0
    v_add_f32_dpp v33, v33, v33 row_ror:1 row_mask:0xf bank_mask:0xf
    v_mov_b32 v34, v32
    v_mov_b32 v35, v33
    s_nop 0
    v_permlane16_swap_b32 v32, v34
    v_permlane16_swap_b32 v33, v35
    v_add_f32 v32, v32, v34
    v_add_f32 v33, v33, v35
    v_mov_b32 v34, v32
    v_mov_b32 v35, v33
    s_nop 0
    v_permlane32_swap_b32 v32, v34
    v_permlane32_swap_b32 v33, v35
    v_add_f32 v32, v32, v34
    v_add_f32 v33, v33, v35
    v_mul_f32 v32, 0x3b000000, v32
    v_mul_f32 v33, 0x3b000000, v33
    v_sub_f32 v36, v16, v32
    v_mul_f32 v34, v36, v36
    v_sub_f32 v36, v17, v32
    v_fmac_f32 v34, v36, v36
    v_sub_f32 v36, v18, v32
    v_fmac_f32 v34, v36, v36
    v_sub_f32 v36, v19, v32
    v_fmac_f32 v34, v36, v36
    v_sub_f32 v36, v20, v32
    v_fmac_f32 v34, v36, v36
    v_sub_f32 v36, v21, v32
    v_fmac_f32 v34, v36, v36
    v_sub_f32 v36, v22, v32
    v_fmac_f32 v34, v36, v36
    v_sub_f32 v36, v23, v32
    v_fmac_f32 v34, v36, v36
    v_sub_f32 v36, v24, v33
    v_mul_f32 v35, v36, v36
    v_sub_f32 v36, v25, v33
    v_fmac_f32 v35, v36, v36
    v_sub_f32 v36, v26, v33
    v_fmac_f32 v35, v36, v36
    v_sub_f32 v36, v27, v33
    v_fmac_f32 v35, v36, v36
    v_sub_f32 v36, v28, v33
    v_fmac_f32 v35, v36, v36
    v_sub_f32 v36, v29, v33
    v_fmac_f32 v35, v36, v36
    v_sub_f32 v36, v30, v33
    v_fmac_f32 v35, v36, v36
    v_sub_f32 v36, v31, v33
    v_fmac_f32 v35, v36, v36
    v_add_f32_dpp v34, v34, v34 row_ror:8 row_mask:0xf bank_mask:0xf
    s_nop 0
    v_add_f32_dpp v35, v35, v35 row_ror:8 row_mask:0xf bank_mask:0xf
    v_add_f32_dpp v34, v34, v34 row_ror:4 row_mask:0xf bank_mask:0xf
    s_nop 0
    v_add_f32_dpp v35, v35, v35 row_ror:4 row_mask:0xf bank_mask:0xf
    v_add_f32_dpp v34, v34, v34 row_ror:2 row_mask:0xf bank_mask:0xf
    s_nop 0
    v_add_f32_dpp v35, v35, v35 row_ror:2 row_mask:0xf bank_mask:0xf
    v_add_f32_dpp v34, v34, v34 row_ror:1 row_mask:0xf bank_mask:0xf
    s_nop 0
    v_add_f32_dpp v35, v35, v35 row_ror:1 row_mask:0xf bank_mask:0xf
    v_mov_b32 v36, v34
    v_mov_b32 v37, v35
    s_nop 0
    v_permlane16_swap_b32 v34, v36
    v_permlane16_swap_b32 v35, v37
    v_add_f32 v34, v34, v36
    v_add_f32 v35, v35, v37
    v_mov_b32 v36, v34
    v_mov_b32 v37, v35
    s_nop 0
    v_permlane32_swap_b32 v34, v36
    v_permlane32_swap_b32 v35, v37
    v_add_f32 v34, v34, v36
    v_add_f32 v35, v35, v37
    v_mul_f32 v34, 0x3b000000, v34
    v_mul_f32 v35, 0x3b000000, v35
    v_cvt_pk_bf16_f32 v36, v32, v33
    v_cvt_pk_bf16_f32 v37, v34, v35
    v_lshlrev_b32 v32, 16, v36
    v_and_b32 v33, s77, v36
    v_lshlrev_b32 v34, 16, v37
    v_and_b32 v35, s77, v37
    v_add_f32 v34, 0x3727c5ac, v34
    v_add_f32 v35, 0x3727c5ac, v35
    v_cvt_pk_bf16_f32 v37, v34, v35
    v_lshlrev_b32 v34, 16, v37
    v_and_b32 v35, s77, v37
    v_sqrt_f32 v34, v34
    v_sqrt_f32 v35, v35
    s_nop 0
    v_cvt_pk_bf16_f32 v37, v34, v35
    v_lshlrev_b32 v34, 16, v37
    v_and_b32 v35, s77, v37
    v_rcp_f32 v34, v34
    v_rcp_f32 v35, v35
    v_sub_f32 v16, v16, v32
    v_sub_f32 v17, v17, v32
    v_sub_f32 v18, v18, v32
    v_sub_f32 v19, v19, v32
    v_sub_f32 v20, v20, v32
    v_sub_f32 v21, v21, v32
    v_sub_f32 v22, v22, v32
    v_sub_f32 v23, v23, v32
    v_sub_f32 v24, v24, v33
    v_sub_f32 v25, v25, v33
    v_sub_f32 v26, v26, v33
    v_sub_f32 v27, v27, v33
    v_sub_f32 v28, v28, v33
    v_sub_f32 v29, v29, v33
    v_sub_f32 v30, v30, v33
    v_sub_f32 v31, v31, v33
    v_cvt_pk_bf16_f32 v8, v16, v17
    v_cvt_pk_bf16_f32 v9, v18, v19
    v_cvt_pk_bf16_f32 v10, v20, v21
    v_cvt_pk_bf16_f32 v11, v22, v23
    v_cvt_pk_bf16_f32 v12, v24, v25
    v_cvt_pk_bf16_f32 v13, v26, v27
    v_cvt_pk_bf16_f32 v14, v28, v29
    v_cvt_pk_bf16_f32 v15, v30, v31
    v_lshlrev_b32 v16, 16, v8
    v_and_b32 v17, s77, v8
    v_lshlrev_b32 v18, 16, v9
    v_and_b32 v19, s77, v9
    v_lshlrev_b32 v20, 16, v10
    v_and_b32 v21, s77, v10
    v_lshlrev_b32 v22, 16, v11
    v_and_b32 v23, s77, v11
    v_lshlrev_b32 v24, 16, v12
    v_and_b32 v25, s77, v12
    v_lshlrev_b32 v26, 16, v13
    v_and_b32 v27, s77, v13
    v_lshlrev_b32 v28, 16, v14
    v_and_b32 v29, s77, v14
    v_lshlrev_b32 v30, 16, v15
    v_and_b32 v31, s77, v15
    v_mul_f32 v16, v16, v34
    v_mul_f32 v17, v17, v34
    v_mul_f32 v18, v18, v34
    v_mul_f32 v19, v19, v34
    v_mul_f32 v20, v20, v34
    v_mul_f32 v21, v21, v34
    v_mul_f32 v22, v22, v34
    v_mul_f32 v23, v23, v34
    v_mul_f32 v24, v24, v35
    v_mul_f32 v25, v25, v35
    v_mul_f32 v26, v26, v35
    v_mul_f32 v27, v27, v35
    v_mul_f32 v28, v28, v35
    v_mul_f32 v29, v29, v35
    v_mul_f32 v30, v30, v35
    v_mul_f32 v31, v31, v35
    v_cvt_pk_bf16_f32 v8, v16, v17
    v_cvt_pk_bf16_f32 v9, v18, v19
    v_cvt_pk_bf16_f32 v10, v20, v21
    v_cvt_pk_bf16_f32 v11, v22, v23
    v_cvt_pk_bf16_f32 v12, v24, v25
    v_cvt_pk_bf16_f32 v13, v26, v27
    v_cvt_pk_bf16_f32 v14, v28, v29
    v_cvt_pk_bf16_f32 v15, v30, v31
    s_sub_u32 s63, s63, 1
    s_cmp_lg_u32 s63, 0
    s_cbranch_scc1 L_ln
    ds_write_b128 v0, v[8:11] offset:2048
    ds_write_b128 v0, v[12:15] offset:3072
    v_bfe_u32 v7, v1, 2, 1
    v_lshlrev_b32 v7, 10, v7
    s_lshl_b32 s73, s79, 8
    s_add_u32 s61, s61, s73
    s_waitcnt lgkmcnt(0)
    s_add_u32 s65, s64, 0x01010101
    v_and_b32 v5, 3, v1
    v_lshlrev_b32 v5, 3, v5
    s_and_b32 s73, s65, 15
    v_bfe_u32 v5, s65, v5, 8
    v_lshl_or_b32 v5, v5, 4, s73
L_gemv2:
    v_bfe_u32 v0, v1, 3, 1
    v_lshl_add_u32 v7, v0, 6, v7
    v_lshl_add_u32 v7, v4, 4, v7
    v_add_u32 v7, s61, v7
    ds_read_b128 v[8:11], v7 offset:2048
    ds_read_b128 v[12:15], v7 offset:2176
    s_waitcnt vmcnt(8)
    v_perm_b32 v16, v52, v48, s69
    v_perm_b32 v20, v52, v48, s70
    v_perm_b32 v17, v60, v56, s69
    v_perm_b32 v21, v60, v56, s70
    v_perm_b32 v18, v68, v64, s69
    v_perm_b32 v22, v68, v64, s70
    v_perm_b32 v19, v76, v72, s69
    v_perm_b32 v23, v76, v72, s70
    v_perm_b32 v24, v53, v49, s69
    v_perm_b32 v28, v53, v49, s70
    v_perm_b32 v25, v61, v57, s69
    v_perm_b32 v29, v61, v57, s70
    v_perm_b32 v26, v69, v65, s69
    v_perm_b32 v30, v69, v65, s70
    v_perm_b32 v27, v77, v73, s69
    v_perm_b32 v31, v77, v73, s70
    v_perm_b32 v32, v54, v50, s69
    v_perm_b32 v36, v54, v50, s70
    v_perm_b32 v33, v62, v58, s69
    v_perm_b32 v37, v62, v58, s70
    v_perm_b32 v34, v70, v66, s69
    v_perm_b32 v38, v70, v66, s70
    v_perm_b32 v35, v78, v74, s69
    v_perm_b32 v39, v78, v74, s70
    v_perm_b32 v40, v55, v51, s69
    v_perm_b32 v44, v55, v51, s70
    v_perm_b32 v41, v63, v59, s69
    v_perm_b32 v45, v63, v59, s70
    v_perm_b32 v42, v71, v67, s69
    v_perm_b32 v46, v71, v67, s70
    v_perm_b32 v43, v79, v75, s69
    v_perm_b32 v47, v79, v75, s70
    s_waitcnt lgkmcnt(0)
    v_mfma_f32_16x16x32_bf16 v[48:51], v[8:11], v[16:19], 0
    v_mfma_f32_16x16x32_bf16 v[52:55], v[8:11], v[20:23], 0
    v_mfma_f32_16x16x32_bf16 v[56:59], v[8:11], v[24:27], 0
    v_mfma_f32_16x16x32_bf16 v[60:63], v[8:11], v[28:31], 0
    v_mfma_f32_16x16x32_bf16 v[64:67], v[8:11], v[32:35], 0
    v_mfma_f32_16x16x32_bf16 v[68:71], v[8:11], v[36:39], 0
    v_mfma_f32_16x16x32_bf16 v[72:75], v[8:11], v[40:43], 0
    v_mfma_f32_16x16x32_bf16 v[76:79], v[8:11], v[44:47], 0
    s_waitcnt vmcnt(0)
    v_perm_b32 v16, v84, v80, s69
    v_perm_b32 v20, v84, v80, s70
    v_perm_b32 v17, v92, v88, s69
    v_perm_b32 v21, v92, v88, s70
    v_perm_b32 v18, v100, v96, s69
    v_perm_b32 v22, v100, v96, s70
    v_perm_b32 v19, v108, v104, s69
    v_perm_b32 v23, v108, v104, s70
    v_perm_b32 v24, v85, v81, s69
    v_perm_b32 v28, v85, v81, s70
    v_perm_b32 v25, v93, v89, s69
    v_perm_b32 v29, v93, v89, s70
    v_perm_b32 v26, v101, v97, s69
    v_perm_b32 v30, v101, v97, s70
    v_perm_b32 v27, v109, v105, s69
    v_perm_b32 v31, v109, v105, s70
    v_perm_b32 v32, v86, v82, s69
    v_perm_b32 v36, v86, v82, s70
    v_perm_b32 v33, v94, v90, s69
    v_perm_b32 v37, v94, v90, s70
    v_perm_b32 v34, v102, v98, s69
    v_perm_b32 v38, v102, v98, s70
    v_perm_b32 v35, v110, v106, s69
    v_perm_b32 v39, v110, v106, s70
    v_perm_b32 v40, v87, v83, s69
    v_perm_b32 v44, v87, v83, s70
    v_perm_b32 v41, v95, v91, s69
    v_perm_b32 v45, v95, v91, s70
    v_perm_b32 v42, v103, v99, s69
    v_perm_b32 v46, v103, v99, s70
    v_perm_b32 v43, v111, v107, s69
    v_perm_b32 v47, v111, v107, s70
    v_mfma_f32_16x16x32_bf16 v[48:51], v[12:15], v[16:19], v[48:51]
    v_mfma_f32_16x16x32_bf16 v[52:55], v[12:15], v[20:23], v[52:55]
    v_mfma_f32_16x16x32_bf16 v[56:59], v[12:15], v[24:27], v[56:59]
    v_mfma_f32_16x16x32_bf16 v[60:63], v[12:15], v[28:31], v[60:63]
    v_mfma_f32_16x16x32_bf16 v[64:67], v[12:15], v[32:35], v[64:67]
    v_mfma_f32_16x16x32_bf16 v[68:71], v[12:15], v[36:39], v[68:71]
    v_mfma_f32_16x16x32_bf16 v[72:75], v[12:15], v[40:43], v[72:75]
    v_mfma_f32_16x16x32_bf16 v[76:79], v[12:15], v[44:47], v[76:79]
    v_and_b32 v7, 1, v4
    v_lshlrev_b32 v7, 8, v7
    v_lshl_add_u32 v7, v6, 5, v7
    v_lshrrev_b32 v0, 1, v4
    v_lshl_add_u32 v7, v0, 4, v7
    v_bfe_u32 v0, v7, 4, 2
    v_lshlrev_b32 v0, 3, v0
    s_and_b32 s73, s65, 15
    v_bfe_u32 v0, s65, v0, 8
    v_lshl_or_b32 v0, v0, 4, s73
    v_mov_b32_dpp v48, v49 row_ror:8 row_mask:0xc bank_mask:0xf
    v_mov_b32_dpp v52, v53 row_ror:8 row_mask:0xc bank_mask:0xf
    v_mov_b32_dpp v56, v57 row_ror:8 row_mask:0xc bank_mask:0xf
    v_mov_b32_dpp v60, v61 row_ror:8 row_mask:0xc bank_mask:0xf
    v_mov_b32_dpp v64, v65 row_ror:8 row_mask:0xc bank_mask:0xf
    v_mov_b32_dpp v68, v69 row_ror:8 row_mask:0xc bank_mask:0xf
    v_mov_b32_dpp v72, v73 row_ror:8 row_mask:0xc bank_mask:0xf
    v_mov_b32_dpp v76, v77 row_ror:8 row_mask:0xc bank_mask:0xf
    v_permlane32_swap_b32 v48, v64
    v_permlane32_swap_b32 v52, v68
    v_permlane32_swap_b32 v56, v72
    v_permlane32_swap_b32 v60, v76
    v_add_f32 v48, v48, v64
    v_add_f32 v49, v52, v68
    v_add_f32 v50, v56, v72
    v_add_f32 v51, v60, v76
    v_add_u32 v51, 0x800, v51
    v_bfi_b32 v51, s66, v0, v51
    v_mov_b32 v52, v7
    s_mov_b32 exec_lo, 0x00ff00ff
    s_mov_b32 exec_hi, 0x00ff00ff
    s_cmp_lt_u32 s3, 2
    s_cbranch_scc1 L_qpub
    buffer_store_dwordx4 v[48:51], v52, s[44:47], s6 offen sc1
    s_mov_b64 exec, -1
    s_branch L_svcmid2
L_qpub:
    buffer_store_dwordx4 v[48:51], v52, s[44:47], s6 offen
    s_mov_b64 exec, -1
    s_cmp_eq_u32 s3, 1
    s_cselect_b32 s62, 3, 0
    s_cbranch_scc1 L_w01k
    v_mov_b32 v12, s67
    v_mov_b32 v15, s65
    s_lshl_b32 s42, s5, 4
    s_add_u32 s42, s42, s78
    s_add_u32 s42, s42, 0x30400
    s_mov_b64 exec, 1
    buffer_store_dwordx4 v[12:15], v3, s[44:47], s42 offen
    s_mov_b64 exec, -1
L_w01k:
    buffer_load_dwordx4 v[16:19], v2, s[8:11], s96 offen offset:0 nt
    buffer_load_dwordx4 v[20:23], v2, s[8:11], s96 offen offset:1024 nt
    buffer_load_dwordx4 v[24:27], v2, s[8:11], s97 offen offset:0 nt
    buffer_load_dwordx4 v[28:31], v2, s[8:11], s97 offen offset:1024 nt
    buffer_load_dwordx4 v[32:35], v2, s[8:11], s98 offen offset:0 nt
    buffer_load_dwordx4 v[36:39], v2, s[8:11], s98 offen offset:1024 nt
    buffer_load_dwordx4 v[40:43], v2, s[8:11], s99 offen offset:0 nt
    buffer_load_dwordx4 v[44:47], v2, s[8:11], s99 offen offset:1024 nt
    s_waitcnt vmcnt(0)
    s_branch L_sphase
L_wk:
    s_cmp_eq_u32 s3, 3
    s_cbranch_scc1 L_w3
L_wk1:
    buffer_load_dwordx4 v[16:19], v2, s[8:11], s96 offen offset:0 nt
    buffer_load_dwordx4 v[20:23], v2, s[8:11], s96 offen offset:1024 nt
    buffer_load_dwordx4 v[24:27], v2, s[8:11], s97 offen offset:0 nt
    buffer_load_dwordx4 v[28:31], v2, s[8:11], s97 offen offset:1024 nt
    s_waitcnt vmcnt(3)
    buffer_load_dwordx4 v[32:35], v2, s[8:11], s98 offen offset:0 nt
    s_waitcnt vmcnt(3)
    buffer_load_dwordx4 v[36:39], v2, s[8:11], s98 offen offset:1024 nt
    s_waitcnt vmcnt(3)
    buffer_load_dwordx4 v[40:43], v2, s[8:11], s99 offen offset:0 nt
    s_waitcnt vmcnt(3)
    buffer_load_dwordx4 v[44:47], v2, s[8:11], s99 offen offset:1024 nt
    s_cmp_eq_u32 s3, 2
    s_cbranch_scc1 L_qg
    s_branch L_wk2
L_w3:
    s_bitcmp0_b32 s5, 3
    s_cselect_b32 s7, 2, 0
    s_lshr_b32 s73, s5, 4
    s_add_u32 s7, s7, s73
    s_lshl_b32 s73, s4, 2
    s_lshr_b32 s79, 0x4020404, s73
    s_and_b32 s79, s79, 15
    s_cmp_ge_u32 s7, s79
    s_cbranch_scc1 L_wk1
    s_lshr_b32 s79, 0xeaa88440, s73
    s_and_b32 s79, s79, 15
    s_add_u32 s79, s79, s7
    s_mov_b32 s52, s32
    s_mov_b32 s53, s33
    s_mov_b32 s54, 0x1c0000
    s_mov_b32 s55, 0x00020000
    s_mov_b32 s56, s30
    s_mov_b32 s57, s31
    s_mov_b32 s58, 0xe00
    s_mov_b32 s59, 0x00020000
    s_mov_b32 s62, 1
    s_add_u32 s73, s5, 2
    s_and_b32 s73, s73, 7
    s_lshl_b32 s42, s73, 7
    s_mul_i32 s6, s73, 0x40000
    s_lshl_b32 s73, s79, 9
    s_add_u32 s6, s6, s73
    s_add_u32 s6, s6, 0xc000
    s_lshl_b32 s73, s79, 17
    s_add_u32 s42, s42, s73
    v_lshlrev_b32 v7, 13, v7
    v_lshl_add_u32 v7, v0, 4, v7
    v_lshrrev_b32 v13, 1, v4
    v_lshlrev_b32 v13, 2, v13
    v_lshl_add_u32 v13, v6, 3, v13
    s_waitcnt vmcnt(0)
    s_mov_b32 m0, 43008
    s_add_u32 s73, s42, 0
    buffer_load_dwordx4 v7, s[52:55], s73 offen offset:0 nt lds
    buffer_load_dwordx4 v7, s[52:55], s73 offen offset:1024 nt lds
    buffer_load_dwordx4 v7, s[52:55], s73 offen offset:2048 nt lds
    buffer_load_dwordx4 v7, s[52:55], s73 offen offset:3072 nt lds
    s_mov_b32 m0, 47104
    s_add_u32 s73, s42, 4096
    buffer_load_dwordx4 v7, s[52:55], s73 offen offset:0 nt lds
    buffer_load_dwordx4 v7, s[52:55], s73 offen offset:1024 nt lds
    buffer_load_dwordx4 v7, s[52:55], s73 offen offset:2048 nt lds
    buffer_load_dwordx4 v7, s[52:55], s73 offen offset:3072 nt lds
    s_mov_b32 m0, 51200
    s_add_u32 s73, s42, 65536
    buffer_load_dwordx4 v7, s[52:55], s73 offen offset:0 nt lds
    buffer_load_dwordx4 v7, s[52:55], s73 offen offset:1024 nt lds
    buffer_load_dwordx4 v7, s[52:55], s73 offen offset:2048 nt lds
    buffer_load_dwordx4 v7, s[52:55], s73 offen offset:3072 nt lds
    s_mov_b32 m0, 55296
    s_add_u32 s73, s42, 69632
    buffer_load_dwordx4 v7, s[52:55], s73 offen offset:0 nt lds
    buffer_load_dwordx4 v7, s[52:55], s73 offen offset:1024 nt lds
    buffer_load_dwordx4 v7, s[52:55], s73 offen offset:2048 nt lds
    buffer_load_dwordx4 v7, s[52:55], s73 offen offset:3072 nt lds
    s_lshl_b32 s73, s79, 8
    buffer_load_dword v14, v13, s[56:59], s73 offen
    buffer_load_dword v15, v13, s[56:59], s73 offen offset:128
    s_waitcnt vmcnt(0)
    buffer_load_dwordx4 v[16:19], v2, s[8:11], s96 offen offset:0 nt
    buffer_load_dwordx4 v[20:23], v2, s[8:11], s96 offen offset:1024 nt
    buffer_load_dwordx4 v[24:27], v2, s[8:11], s97 offen offset:0 nt
    buffer_load_dwordx4 v[28:31], v2, s[8:11], s97 offen offset:1024 nt
    buffer_load_dwordx4 v[32:35], v2, s[8:11], s98 offen offset:0 nt
    buffer_load_dwordx4 v[36:39], v2, s[8:11], s98 offen offset:1024 nt
    buffer_load_dwordx4 v[40:43], v2, s[8:11], s99 offen offset:0 nt
    buffer_load_dwordx4 v[44:47], v2, s[8:11], s99 offen offset:1024 nt
    s_waitcnt vmcnt(0)
    s_waitcnt vmcnt(18)
    s_branch L_sphase
L_wk2:
    s_waitcnt vmcnt(0)
    s_branch L_sphase
L_qg:
    v_lshlrev_b32 v7, 9, v4
    v_lshl_add_u32 v7, v6, 4, v7
    v_and_b32 v9, 0x1ff, v3
    s_and_b32 s73, s5, 1
    s_lshl_b32 s73, s73, 8
    s_add_u32 s42, s78, s73
    s_add_u32 s43, s78, 0x30400
    s_add_u32 s56, s42, 0x34000
    s_add_u32 s57, s42, 0x35000
    s_add_u32 s58, s42, 0x36000
    s_add_u32 s59, s42, 0x37000
    s_waitcnt vmcnt(0) lgkmcnt(0)
    s_add_u32 s65, s64, 0x01010101
    v_and_b32 v5, 3, v1
    v_lshlrev_b32 v5, 3, v5
    s_and_b32 s73, s65, 15
    v_bfe_u32 v5, s65, v5, 8
    v_lshl_or_b32 v5, v5, 4, s73
    s_mov_b32 s75, 200000
    s_mov_b32 s7, 0
L_qpoll:
    buffer_load_dwordx4 v[80:83], v7, s[44:47], s56 offen offset:0 sc1
    buffer_load_dwordx4 v[84:87], v7, s[44:47], s56 offen offset:2048 sc1
    buffer_load_dwordx4 v[88:91], v7, s[44:47], s57 offen offset:0 sc1
    buffer_load_dwordx4 v[92:95], v7, s[44:47], s57 offen offset:2048 sc1
    buffer_load_dwordx4 v[96:99], v7, s[44:47], s58 offen offset:0 sc1
    buffer_load_dwordx4 v[100:103], v7, s[44:47], s58 offen offset:2048 sc1
    buffer_load_dwordx4 v[104:107], v7, s[44:47], s59 offen offset:0 sc1
    buffer_load_dwordx4 v[108:111], v7, s[44:47], s59 offen offset:2048 sc1
    buffer_load_dwordx4 v[112:115], v9, s[44:47], s43 offen sc1
    s_waitcnt vmcnt(0)
    v_xor_b32 v83, v5, v83
    v_xor_b32 v87, v5, v87
    v_xor_b32 v91, v5, v91
    v_xor_b32 v95, v5, v95
    v_xor_b32 v99, v5, v99
    v_xor_b32 v103, v5, v103
    v_xor_b32 v107, v5, v107
    v_xor_b32 v111, v5, v111
    v_or3_b32 v8, v83, v87, v91
    v_or3_b32 v8, v8, v95, v99
    v_or3_b32 v8, v8, v103, v107
    v_or_b32 v8, v8, v111
    v_and_b32 v8, s66, v8
    v_bitop3_b32 v8, v115, s65, v8 bitop3:0xbe
    v_cmp_ne_u32 vcc, 0, v8
    s_cbranch_vccz L_qok
    s_sub_u32 s75, s75, 1
    s_cmp_eq_u32 s75, 0
    s_cbranch_scc1 L_qok
    s_sleep 8
    s_cmp_gt_u32 s75, 199996
    s_cbranch_scc1 L_qpoll
    s_xor_b32 s56, s56, 0x30000
    s_xor_b32 s57, s57, 0x30000
    s_xor_b32 s58, s58, 0x30000
    s_xor_b32 s59, s59, 0x30000
    s_xor_b32 s43, s43, 0x30000
    s_cmp_lg_u32 s7, 0
    s_cbranch_scc1 L_qpoll
    s_mov_b32 s7, 1
L_qrep:
    s_lshl_b32 s61, s5, 9
    s_add_u32 s61, s61, s78
    s_add_u32 s61, s61, 0x4000
    s_add_u32 s60, s61, 0x30000
    s_mov_b32 s63, 200000
L_qrep2:
    buffer_load_dwordx4 v[116:119], v9, s[44:47], s60 offen sc1
    s_waitcnt vmcnt(0)
    v_xor_b32 v8, v5, v119
    v_and_b32 v8, s66, v8
    v_cmp_ne_u32 vcc, 0, v8
    s_cbranch_vccz L_qrep3
    s_sub_u32 s63, s63, 1
    s_cmp_lg_u32 s63, 0
    s_cbranch_scc1 L_qrep2
L_qrep3:
    buffer_store_dwordx4 v[116:119], v9, s[44:47], s61 offen sc1
    v_mov_b32 v120, s67
    v_mov_b32 v123, s65
    s_lshl_b32 s61, s5, 4
    s_add_u32 s61, s61, s78
    s_add_u32 s61, s61, 0x400
    s_mov_b64 exec, 1
    buffer_store_dwordx4 v[120:123], v3, s[44:47], s61 offen sc1
    s_mov_b64 exec, -1
    s_cmp_eq_u32 s7, 1
    s_cbranch_scc1 L_qpoll
    s_branch L_qsum
L_qok:
    v_cmp_ne_u32 vcc, s67, v112
    s_cmp_eq_u64 vcc, 0
    s_cselect_b32 s43, 2, 1
    s_cbranch_scc1 L_qsum
    s_cmp_lg_u32 s7, 0
    s_cbranch_scc1 L_qsum
    s_mov_b32 s7, 2
    s_branch L_qrep
L_qsum:
    v_add_f32 v80, v80, v88
    v_add_f32 v96, v96, v104
    v_add_f32 v81, v81, v89
    v_add_f32 v97, v97, v105
    v_add_f32 v82, v82, v90
    v_add_f32 v98, v98, v106
    v_add_f32 v83, v83, v91
    v_add_f32 v99, v99, v107
    v_add_f32 v84, v84, v92
    v_add_f32 v100, v100, v108
    v_add_f32 v85, v85, v93
    v_add_f32 v101, v101, v109
    v_add_f32 v86, v86, v94
    v_add_f32 v102, v102, v110
    v_add_f32 v87, v87, v95
    v_add_f32 v103, v103, v111
    v_add_f32 v80, v80, v96
    v_add_f32 v81, v81, v97
    v_add_f32 v82, v82, v98
    v_add_f32 v83, v83, v99
    v_add_f32 v84, v84, v100
    v_add_f32 v85, v85, v101
    v_add_f32 v86, v86, v102
    v_add_f32 v87, v87, v103
    v_cvt_pk_bf16_f32 v8, v80, v81
    v_cvt_pk_bf16_f32 v9, v82, v83
    v_cvt_pk_bf16_f32 v10, v84, v85
    v_cvt_pk_bf16_f32 v11, v86, v87
    v_lshlrev_b32 v7, 3, v1
    ds_write_b64 v7, v[8:9] offset:0
    ds_write_b64 v7, v[10:11] offset:512
    v_mov_b32 v7, 1024
    v_mov_b32 v12, s43
    ds_write_b32 v7, v12
    s_branch L_sphase
L_codeend:
.section .rodata,"a"
.p2align 6
.amdhsa_kernel recurrent_scan__gqa_block_cached__mixer_channel_mlp__decode_kernel
.amdhsa_next_free_vgpr 128
.amdhsa_next_free_sgpr 102
.amdhsa_accum_offset 128
.amdhsa_group_segment_fixed_size 0
.amdhsa_kernarg_size 104
.amdhsa_user_sgpr_count 2
.amdhsa_user_sgpr_kernarg_segment_ptr 1
.amdhsa_system_sgpr_workgroup_id_x 1
.end_amdhsa_kernel
```
